```python
import torch

def _softmax(x, axis=-1):
    return torch.softmax(x, dim=axis)

def _gelu(x):
    return torch.nn.functional.gelu(x, approximate='tanh')

def _silu(x):
    return torch.nn.functional.silu(x)

def _sigmoid(x):
    return torch.sigmoid(x)

def _layernorm(x, axis=-1, eps=1e-05):
    m = x.mean(dim=axis, keepdim=True)
    v = x.var(dim=axis, keepdim=True, unbiased=False)
    return (x - m) / torch.sqrt(v + eps)

def _scatter_add(tgt, idx, src, axis=0):
    return tgt.clone().index_add_(axis, idx, src)

def _segment_sum(src, seg, n):
    out = torch.zeros((n,) + src.shape[1:], dtype=src.dtype)
    return out.index_add_(0, seg, src)

def _pad(x, pw):
    flat = tuple((v for pair in reversed(pw) for v in pair))
    return torch.nn.functional.pad(x, flat)
kernel_name = 'standalone__tree_speculative_verify_tree_attention_over_candidate_token_tree__decode'

def setup_inputs():

    _w = lambda a: (lambda t: t.to(torch.bfloat16) if t.is_floating_point() else t)(torch.as_tensor(a))
    B, Hq, Hkv, T, C, D = (2, 32, 32, 1, 8192, 192)
    tree_mask = torch.zeros((B, T, T), dtype=float)
    for b in range(B):
        parent = torch.zeros(T, dtype=torch.int64)
        for i in range(1, T):
            parent[i] = int(torch.randint(0, i, (1,)).item())
        for i in range(T):
            j = i
            tree_mask[b, i, j] = 1.0
            while j > 0:
                j = parent[j]
                tree_mask[b, i, j] = 1.0
    return {'q': _w((lambda *s: torch.randn(*s, dtype=torch.bfloat16) * 0.8)(B, Hq, T, D)), 'k_cache': _w((lambda *s: torch.randn(*s, dtype=torch.bfloat16) * 0.8)(B, Hkv, C, D)), 'v_cache': _w((lambda *s: torch.randn(*s, dtype=torch.bfloat16) * 0.05)(B, Hkv, C, D)), 'k_tree': _w((lambda *s: torch.randn(*s, dtype=torch.bfloat16) * 0.8)(B, Hkv, T, D)), 'v_tree': _w((lambda *s: torch.randn(*s, dtype=torch.bfloat16) * 0.05)(B, Hkv, T, D)), 'tree_mask': _w(tree_mask)}

def reference(q, k_cache, v_cache, k_tree, v_tree, tree_mask):
    B, Hq, T, D = q.shape
    Hkv, C = (k_cache.shape[1], k_cache.shape[2])
    rep = Hq // Hkv
    kc = (lambda x, n, axis: torch.repeat_interleave(x, n, dim=axis))(k_cache, rep, axis=1)
    vc = (lambda x, n, axis: torch.repeat_interleave(x, n, dim=axis))(v_cache, rep, axis=1)
    kt = (lambda x, n, axis: torch.repeat_interleave(x, n, dim=axis))(k_tree, rep, axis=1)
    vt = (lambda x, n, axis: torch.repeat_interleave(x, n, dim=axis))(v_tree, rep, axis=1)
    k = torch.concatenate([kc, kt], axis=2)
    v = torch.concatenate([vc, vt], axis=2)
    scale = D ** (-0.5)
    scores = torch.einsum('bhqd,bhkd->bhqk', q, k) * scale
    ctx_mask = torch.ones((B, 1, T, C), dtype=scores.dtype)
    tm = tree_mask[:, None, :, :].clone()
    full_mask = torch.concatenate([ctx_mask, tm], axis=-1)
    scores = scores + (1.0 - full_mask) * -1000000000.0
    p = _softmax(scores, axis=-1)
    return torch.einsum('bhqk,bhkd->bhqd', p, v)
```

```asm
; @launch grid=(256,1,1) block=(320,1,1) lds=88064
.amdgcn_target "amdgcn-amd-amdhsa--gfx950"
.text
.globl standalone__tree_speculative_verify_tree_attention_over_candidate_token_tree__decode_kernel
.p2align 8
.type standalone__tree_speculative_verify_tree_attention_over_candidate_token_tree__decode_kernel,@function
standalone__tree_speculative_verify_tree_attention_over_candidate_token_tree__decode_kernel:
    s_load_dwordx2 s[24:25], s[0:1], 8
    s_cmp_ge_u32 s2, 256
    s_cbranch_scc1 L_end
    v_lshrrev_b32 v2, 6, v0
    v_and_b32 v8, 63, v0
    v_readfirstlane_b32 s38, v2
    v_lshrrev_b32 v2, 3, v8
    v_and_b32 v20, 7, v8
    v_mul_u32_u24 v1, 384, v2
    v_lshlrev_b32 v20, 4, v20
    v_add_u32 v1, v1, v20
    s_and_b32 s36, s2, 7
    s_lshr_b32 s43, s2, 7
    s_lshl_b32 s36, s36, 1
    s_add_u32 s36, s36, s43
    s_bfe_u32 s37, s2, 262147
    s_mul_i32 s47, s36, 3145728
    s_lshl_b32 s46, s37, 2
    s_add_u32 s46, s46, s38
    s_mul_i32 s43, s46, 3072
    s_add_u32 s39, s47, s43
    s_mov_b32 s70, s47
    s_mov_b32 s26, 201326592
    s_mov_b32 s27, 0x00020000
    s_cmp_eq_u32 s38, 4
    s_cbranch_scc1 L_helper
    s_add_u32 s46, s46, 8
    s_and_b32 s46, s46, 63
    s_mul_i32 s43, s46, 3072
    s_add_u32 s47, s47, 196608
    s_add_u32 s29, s47, s43
    s_waitcnt lgkmcnt(0)
    buffer_load_dwordx4 v[68:71], v1, s[24:27], s39 offen offset:0 nt
    buffer_load_dwordx4 v[72:75], v1, s[24:27], s39 offen offset:128 nt
    buffer_load_dwordx4 v[76:79], v1, s[24:27], s39 offen offset:256 nt
    buffer_load_dwordx4 v[80:83], v1, s[24:27], s29 offen offset:0 nt
    buffer_load_dwordx4 v[84:87], v1, s[24:27], s29 offen offset:128 nt
    buffer_load_dwordx4 v[88:91], v1, s[24:27], s29 offen offset:256 nt
    s_load_dwordx16 s[4:19], s[0:1], 0
    s_mov_b32 s68, 196608
    s_mov_b32 s69, 47382528
    s_mov_b32 s40, 1
    v_mov_b32 v55, 0
    s_add_u32 s40, s40, 1
    s_and_b32 s43, s40, 15
    s_cselect_b32 s43, s68, s69
    s_add_u32 s47, s47, s43
    s_add_u32 s46, s46, 8
    s_and_b32 s46, s46, 63
    s_mul_i32 s43, s46, 3072
    s_add_u32 s39, s47, s43
    s_load_dwordx2 s[20:21], s[0:1], 64
    s_mov_b32 s71, 499
    s_lshl_b32 s28, s38, 6
    s_mov_b32 s30, 0
    s_mul_i32 s43, s38, 16384
    s_add_u32 s43, s43, 2048
    v_lshlrev_b32 v6, 2, v8
    v_add_u32 v6, s43, v6
    v_mov_b32 v4, 0xf149f2ca
    s_waitcnt vmcnt(3)
    buffer_load_dwordx4 v[92:95], v1, s[24:27], s39 offen offset:0 nt
    buffer_load_dwordx4 v[96:99], v1, s[24:27], s39 offen offset:128 nt
    buffer_load_dwordx4 v[100:103], v1, s[24:27], s39 offen offset:256 nt
    s_add_u32 s40, s40, 1
    s_and_b32 s43, s40, 15
    s_cselect_b32 s43, s68, s69
    s_add_u32 s47, s47, s43
    s_add_u32 s46, s46, 8
    s_and_b32 s46, s46, 63
    s_mul_i32 s43, s46, 3072
    s_add_u32 s39, s47, s43
    s_waitcnt vmcnt(3)
    buffer_load_dwordx4 v[104:107], v1, s[24:27], s39 offen offset:0 nt
    buffer_load_dwordx4 v[108:111], v1, s[24:27], s39 offen offset:128 nt
    buffer_load_dwordx4 v[112:115], v1, s[24:27], s39 offen offset:256 nt
    s_add_u32 s40, s40, 1
    s_and_b32 s43, s40, 15
    s_cselect_b32 s43, s68, s69
    s_add_u32 s47, s47, s43
    s_add_u32 s46, s46, 8
    s_and_b32 s46, s46, 63
    s_mul_i32 s43, s46, 3072
    s_add_u32 s39, s47, s43
    s_barrier
    ds_read_b128 v[56:59], v20 offset:512
    ds_read_b128 v[60:63], v20 offset:640
    ds_read_b128 v[64:67], v20 offset:768
    s_waitcnt lgkmcnt(0)
    s_mov_b32 s41, 0
    s_nop 2
.p2align 6
L_kloop:
    s_waitcnt vmcnt(9)
    v_dot2_f32_bf16 v12, v68, v56, 0
    v_dot2_f32_bf16 v13, v72, v60, 0
    v_dot2_f32_bf16 v14, v76, v64, 0
    v_dot2_f32_bf16 v12, v69, v57, v12
    v_dot2_f32_bf16 v13, v73, v61, v13
    v_dot2_f32_bf16 v14, v77, v65, v14
    v_dot2_f32_bf16 v12, v70, v58, v12
    v_dot2_f32_bf16 v13, v74, v62, v13
    v_dot2_f32_bf16 v14, v78, v66, v14
    v_dot2_f32_bf16 v12, v71, v59, v12
    v_dot2_f32_bf16 v13, v75, v63, v13
    v_dot2_f32_bf16 v14, v79, v67, v14
    s_nop 1
    v_add_f32 v12, v12, v13
    v_add_f32 v12, v12, v14
    s_nop 1
    v_add_f32_dpp v12, v12, v12 quad_perm:[1,0,3,2] row_mask:0xf bank_mask:0xf
    s_nop 1
    v_add_f32_dpp v12, v12, v12 quad_perm:[2,3,0,1] row_mask:0xf bank_mask:0xf
    s_nop 1
    v_add_f32_dpp v12, v12, v12 row_half_mirror row_mask:0xf bank_mask:0xf
    ds_write_b32 v6, v12 offset:0
    v_max_f32 v4, v4, v12
    s_add_u32 s28, s28, s71
    s_lshr_b32 s29, s28, 8
    s_and_b32 s28, s28, 255
    s_waitcnt vmcnt(6)
    s_cmp_gt_u32 s29, 2
    s_cbranch_scc1 L_go0
    s_waitcnt vmcnt(3)
    s_cmp_gt_u32 s29, 1
    s_cbranch_scc1 L_go0
    s_waitcnt vmcnt(2)
L_go0:
    buffer_load_dwordx4 v[68:71], v1, s[24:27], s39 offen offset:0 nt
    buffer_load_dwordx4 v[72:75], v1, s[24:27], s39 offen offset:128 nt
    buffer_load_dwordx4 v[76:79], v1, s[24:27], s39 offen offset:256 nt
    s_add_u32 s40, s40, 1
    s_and_b32 s43, s40, 15
    s_cselect_b32 s43, s68, s69
    s_add_u32 s47, s47, s43
    s_cmp_eq_u32 s40, 64
    s_cselect_b32 s24, s8, s24
    s_cselect_b32 s25, s9, s25
    s_cselect_b32 s47, s70, s47
    s_add_u32 s46, s46, 8
    s_and_b32 s46, s46, 63
    s_mul_i32 s43, s46, 3072
    s_add_u32 s39, s47, s43
    s_waitcnt vmcnt(9)
    v_dot2_f32_bf16 v12, v80, v56, 0
    v_dot2_f32_bf16 v13, v84, v60, 0
    v_dot2_f32_bf16 v14, v88, v64, 0
    v_dot2_f32_bf16 v12, v81, v57, v12
    v_dot2_f32_bf16 v13, v85, v61, v13
    v_dot2_f32_bf16 v14, v89, v65, v14
    v_dot2_f32_bf16 v12, v82, v58, v12
    v_dot2_f32_bf16 v13, v86, v62, v13
    v_dot2_f32_bf16 v14, v90, v66, v14
    v_dot2_f32_bf16 v12, v83, v59, v12
    v_dot2_f32_bf16 v13, v87, v63, v13
    v_dot2_f32_bf16 v14, v91, v67, v14
    s_nop 1
    v_add_f32 v12, v12, v13
    v_add_f32 v12, v12, v14
    s_nop 1
    v_add_f32_dpp v12, v12, v12 quad_perm:[1,0,3,2] row_mask:0xf bank_mask:0xf
    s_nop 1
    v_add_f32_dpp v12, v12, v12 quad_perm:[2,3,0,1] row_mask:0xf bank_mask:0xf
    s_nop 1
    v_add_f32_dpp v12, v12, v12 row_half_mirror row_mask:0xf bank_mask:0xf
    ds_write_b32 v6, v12 offset:256
    v_max_f32 v4, v4, v12
    s_add_u32 s28, s28, s71
    s_lshr_b32 s29, s28, 8
    s_and_b32 s28, s28, 255
    s_waitcnt vmcnt(6)
    s_cmp_gt_u32 s29, 2
    s_cbranch_scc1 L_go1
    s_waitcnt vmcnt(3)
    s_cmp_gt_u32 s29, 1
    s_cbranch_scc1 L_go1
    s_waitcnt vmcnt(2)
L_go1:
    buffer_load_dwordx4 v[80:83], v1, s[24:27], s39 offen offset:0 nt
    buffer_load_dwordx4 v[84:87], v1, s[24:27], s39 offen offset:128 nt
    buffer_load_dwordx4 v[88:91], v1, s[24:27], s39 offen offset:256 nt
    s_add_u32 s40, s40, 1
    s_and_b32 s43, s40, 15
    s_cselect_b32 s43, s68, s69
    s_add_u32 s47, s47, s43
    s_cmp_eq_u32 s40, 64
    s_cselect_b32 s24, s8, s24
    s_cselect_b32 s25, s9, s25
    s_cselect_b32 s47, s70, s47
    s_add_u32 s46, s46, 8
    s_and_b32 s46, s46, 63
    s_mul_i32 s43, s46, 3072
    s_add_u32 s39, s47, s43
    s_waitcnt vmcnt(9)
    v_dot2_f32_bf16 v12, v92, v56, 0
    v_dot2_f32_bf16 v13, v96, v60, 0
    v_dot2_f32_bf16 v14, v100, v64, 0
    v_dot2_f32_bf16 v12, v93, v57, v12
    v_dot2_f32_bf16 v13, v97, v61, v13
    v_dot2_f32_bf16 v14, v101, v65, v14
    v_dot2_f32_bf16 v12, v94, v58, v12
    v_dot2_f32_bf16 v13, v98, v62, v13
    v_dot2_f32_bf16 v14, v102, v66, v14
    v_dot2_f32_bf16 v12, v95, v59, v12
    v_dot2_f32_bf16 v13, v99, v63, v13
    v_dot2_f32_bf16 v14, v103, v67, v14
    s_nop 1
    v_add_f32 v12, v12, v13
    v_add_f32 v12, v12, v14
    s_nop 1
    v_add_f32_dpp v12, v12, v12 quad_perm:[1,0,3,2] row_mask:0xf bank_mask:0xf
    s_nop 1
    v_add_f32_dpp v12, v12, v12 quad_perm:[2,3,0,1] row_mask:0xf bank_mask:0xf
    s_nop 1
    v_add_f32_dpp v12, v12, v12 row_half_mirror row_mask:0xf bank_mask:0xf
    ds_write_b32 v6, v12 offset:512
    v_max_f32 v4, v4, v12
    s_add_u32 s28, s28, s71
    s_lshr_b32 s29, s28, 8
    s_and_b32 s28, s28, 255
    s_waitcnt vmcnt(6)
    s_cmp_gt_u32 s29, 2
    s_cbranch_scc1 L_go2
    s_waitcnt vmcnt(3)
    s_cmp_gt_u32 s29, 1
    s_cbranch_scc1 L_go2
    s_waitcnt vmcnt(2)
L_go2:
    buffer_load_dwordx4 v[92:95], v1, s[24:27], s39 offen offset:0 nt
    buffer_load_dwordx4 v[96:99], v1, s[24:27], s39 offen offset:128 nt
    buffer_load_dwordx4 v[100:103], v1, s[24:27], s39 offen offset:256 nt
    s_add_u32 s40, s40, 1
    s_and_b32 s43, s40, 15
    s_cselect_b32 s43, s68, s69
    s_add_u32 s47, s47, s43
    s_cmp_eq_u32 s40, 64
    s_cselect_b32 s24, s8, s24
    s_cselect_b32 s25, s9, s25
    s_cselect_b32 s47, s70, s47
    s_add_u32 s46, s46, 8
    s_and_b32 s46, s46, 63
    s_mul_i32 s43, s46, 3072
    s_add_u32 s39, s47, s43
    s_waitcnt vmcnt(9)
    v_dot2_f32_bf16 v12, v104, v56, 0
    v_dot2_f32_bf16 v13, v108, v60, 0
    v_dot2_f32_bf16 v14, v112, v64, 0
    v_dot2_f32_bf16 v12, v105, v57, v12
    v_dot2_f32_bf16 v13, v109, v61, v13
    v_dot2_f32_bf16 v14, v113, v65, v14
    v_dot2_f32_bf16 v12, v106, v58, v12
    v_dot2_f32_bf16 v13, v110, v62, v13
    v_dot2_f32_bf16 v14, v114, v66, v14
    v_dot2_f32_bf16 v12, v107, v59, v12
    v_dot2_f32_bf16 v13, v111, v63, v13
    v_dot2_f32_bf16 v14, v115, v67, v14
    s_nop 1
    v_add_f32 v12, v12, v13
    v_add_f32 v12, v12, v14
    s_nop 1
    v_add_f32_dpp v12, v12, v12 quad_perm:[1,0,3,2] row_mask:0xf bank_mask:0xf
    s_nop 1
    v_add_f32_dpp v12, v12, v12 quad_perm:[2,3,0,1] row_mask:0xf bank_mask:0xf
    s_nop 1
    v_add_f32_dpp v12, v12, v12 row_half_mirror row_mask:0xf bank_mask:0xf
    ds_write_b32 v6, v12 offset:768
    v_max_f32 v4, v4, v12
    s_add_u32 s28, s28, s71
    s_lshr_b32 s29, s28, 8
    s_and_b32 s28, s28, 255
    s_waitcnt vmcnt(6)
    s_cmp_gt_u32 s29, 2
    s_cbranch_scc1 L_go3
    s_waitcnt vmcnt(3)
    s_cmp_gt_u32 s29, 1
    s_cbranch_scc1 L_go3
    s_waitcnt vmcnt(2)
L_go3:
    buffer_load_dwordx4 v[104:107], v1, s[24:27], s39 offen offset:0 nt
    buffer_load_dwordx4 v[108:111], v1, s[24:27], s39 offen offset:128 nt
    buffer_load_dwordx4 v[112:115], v1, s[24:27], s39 offen offset:256 nt
    s_add_u32 s40, s40, 1
    s_and_b32 s43, s40, 15
    s_cselect_b32 s43, s68, s69
    s_add_u32 s47, s47, s43
    s_cmp_eq_u32 s40, 64
    s_cselect_b32 s24, s8, s24
    s_cselect_b32 s25, s9, s25
    s_cselect_b32 s47, s70, s47
    s_add_u32 s46, s46, 8
    s_and_b32 s46, s46, 63
    s_mul_i32 s43, s46, 3072
    s_add_u32 s39, s47, s43
    v_add_u32 v6, 1024, v6
    s_add_u32 s41, s41, 4
    s_memrealtime s[32:33]
    ds_read_b96 v[52:54], v55 offset:16
    s_add_u32 s30, s30, 4
    s_and_b32 s43, s41, 7
    s_xor_b32 s29, s38, 1
    s_or_b32 s43, s43, s29
    s_waitcnt lgkmcnt(0)
    s_cbranch_scc1 L_nopt4
    s_lshr_b32 s43, s30, 1
    s_or_b32 s29, s32, 1
    v_mov_b32 v3, s43
    v_mov_b32 v15, s29
    ds_write_b32 v3, v15 offset:60
L_nopt4:
    v_readfirstlane_b32 s29, v52
    v_readfirstlane_b32 s43, v53
    v_readfirstlane_b32 s31, v54
    s_cmp_eq_u32 s29, 0
    s_cbranch_scc1 L_noctl4
    s_sub_i32 s29, s30, s29
    s_sub_i32 s43, s32, s43
    s_mul_i32 s31, s31, s29
    s_ashr_i32 s31, s31, 4
    s_sub_i32 s43, s43, s31
    s_max_i32 s43, s43, -1000
    s_min_i32 s43, s43, 1000
    s_mul_i32 s43, s43, 426
    s_ashr_i32 s43, s43, 8
    s_add_i32 s43, s43, 499
    s_max_i32 s43, s43, 256
    s_min_i32 s71, s43, 768
L_noctl4:
    s_and_b32 s43, s41, 15
    s_cbranch_scc0 L_kround
    s_branch L_kloop
L_kround:
    s_cmp_eq_u32 s41, 32
    s_cbranch_scc1 L_kh32
    s_cmp_eq_u32 s41, 48
    s_cbranch_scc1 L_kh48
    s_cmp_eq_u32 s41, 64
    s_cbranch_scc1 L_kdone
L_kh16:
    s_nop 2
    ds_read_b128 v[56:59], v20 offset:896
    ds_read_b128 v[60:63], v20 offset:1024
    ds_read_b128 v[64:67], v20 offset:1152
    v_max_f32_dpp v4, v4, v4 row_ror:8 row_mask:0xf bank_mask:0xf
    v_mov_b32 v15, v4
    s_nop 1
    v_permlane16_swap_b32 v4, v15
    v_max_f32 v4, v4, v15
    v_mov_b32 v15, v4
    s_nop 1
    v_permlane32_swap_b32 v4, v15
    v_max_f32 v4, v4, v15
    s_nop 0
    v_readfirstlane_b32 s72, v4
    v_mov_b32 v4, 0xf149f2ca
    s_waitcnt lgkmcnt(0)
    s_nop 1
    s_branch L_kloop
L_kh32:
    s_nop 2
    ds_read_b128 v[56:59], v20 offset:1280
    ds_read_b128 v[60:63], v20 offset:1408
    ds_read_b128 v[64:67], v20 offset:1536
    v_max_f32_dpp v4, v4, v4 row_ror:8 row_mask:0xf bank_mask:0xf
    v_mov_b32 v15, v4
    s_nop 1
    v_permlane16_swap_b32 v4, v15
    v_max_f32 v4, v4, v15
    v_mov_b32 v15, v4
    s_nop 1
    v_permlane32_swap_b32 v4, v15
    v_max_f32 v4, v4, v15
    s_nop 0
    v_readfirstlane_b32 s73, v4
    v_mov_b32 v4, 0xf149f2ca
    s_waitcnt lgkmcnt(0)
    s_nop 1
    s_branch L_kloop
L_kh48:
    s_nop 2
    ds_read_b128 v[56:59], v20 offset:1664
    ds_read_b128 v[60:63], v20 offset:1792
    ds_read_b128 v[64:67], v20 offset:1920
    v_max_f32_dpp v4, v4, v4 row_ror:8 row_mask:0xf bank_mask:0xf
    v_mov_b32 v15, v4
    s_nop 1
    v_permlane16_swap_b32 v4, v15
    v_max_f32 v4, v4, v15
    v_mov_b32 v15, v4
    s_nop 1
    v_permlane32_swap_b32 v4, v15
    v_max_f32 v4, v4, v15
    s_nop 0
    v_readfirstlane_b32 s74, v4
    v_mov_b32 v4, 0xf149f2ca
    s_waitcnt lgkmcnt(0)
    s_nop 1
    s_branch L_kloop
L_kdone:
    s_nop 2
    v_max_f32_dpp v4, v4, v4 row_ror:8 row_mask:0xf bank_mask:0xf
    v_mov_b32 v15, v4
    s_nop 1
    v_permlane16_swap_b32 v4, v15
    v_max_f32 v4, v4, v15
    v_mov_b32 v15, v4
    s_nop 1
    v_permlane32_swap_b32 v4, v15
    v_max_f32 v4, v4, v15
    s_nop 0
    v_readfirstlane_b32 s75, v4
    v_mov_b32 v4, 0xf149f2ca
    s_waitcnt lgkmcnt(0)
    v_subrev_u32 v6, 16384, v6
    ds_read_b32 v2, v6
    v_lshlrev_b32 v19, 4, v0
    v_add_u32 v19, 67584, v19
    s_mov_b32 s44, 0xaaaaaaaa
    s_mov_b32 s45, 0xaaaaaaaa
    s_mov_b32 s42, 0x3dd53b95
    v_mov_b32 v5, 0
    v_mov_b32 v28, 0
    v_mov_b32 v29, 0
    v_mov_b32 v30, 0
    v_mov_b32 v31, 0
    v_mov_b32 v32, 0
    v_mov_b32 v33, 0
    v_mov_b32 v34, 0
    v_mov_b32 v35, 0
    v_mov_b32 v36, 0
    v_mov_b32 v37, 0
    v_mov_b32 v38, 0
    v_mov_b32 v39, 0
    v_mov_b32 v40, 0
    v_mov_b32 v41, 0
    v_mov_b32 v42, 0
    v_mov_b32 v43, 0
    v_mov_b32 v44, 0
    v_mov_b32 v45, 0
    v_mov_b32 v46, 0
    v_mov_b32 v47, 0
    v_mov_b32 v48, 0
    v_mov_b32 v49, 0
    v_mov_b32 v50, 0
    v_mov_b32 v51, 0
    v_mov_b32 v4, s72
    s_waitcnt lgkmcnt(0)
    s_mov_b32 s41, 0
    s_nop 2
.p2align 6
L_vloop:
    s_waitcnt vmcnt(9)
    v_sub_f32 v10, v2, v4
    ds_read_b32 v2, v6 offset:256
    v_mul_f32 v10, s42, v10
    v_exp_f32 v10, v10
    s_nop 0
    v_cvt_pk_bf16_f32 v10, 0, v10
    v_lshrrev_b32 v11, 16, v10
    v_add_f32 v5, v5, v10
    v_dot2c_f32_bf16 v28, v68, v11
    v_dot2c_f32_bf16 v29, v68, v10
    v_dot2c_f32_bf16 v30, v69, v11
    v_dot2c_f32_bf16 v31, v69, v10
    v_dot2c_f32_bf16 v32, v70, v11
    v_dot2c_f32_bf16 v33, v70, v10
    v_dot2c_f32_bf16 v34, v71, v11
    v_dot2c_f32_bf16 v35, v71, v10
    v_dot2c_f32_bf16 v36, v72, v11
    v_dot2c_f32_bf16 v37, v72, v10
    v_dot2c_f32_bf16 v38, v73, v11
    v_dot2c_f32_bf16 v39, v73, v10
    v_dot2c_f32_bf16 v40, v74, v11
    v_dot2c_f32_bf16 v41, v74, v10
    v_dot2c_f32_bf16 v42, v75, v11
    v_dot2c_f32_bf16 v43, v75, v10
    v_dot2c_f32_bf16 v44, v76, v11
    v_dot2c_f32_bf16 v45, v76, v10
    v_dot2c_f32_bf16 v46, v77, v11
    v_dot2c_f32_bf16 v47, v77, v10
    v_dot2c_f32_bf16 v48, v78, v11
    v_dot2c_f32_bf16 v49, v78, v10
    v_dot2c_f32_bf16 v50, v79, v11
    v_dot2c_f32_bf16 v51, v79, v10
    s_waitcnt lgkmcnt(0)
    s_add_u32 s28, s28, s71
    s_lshr_b32 s29, s28, 8
    s_and_b32 s28, s28, 255
    s_waitcnt vmcnt(6)
    s_cmp_gt_u32 s29, 2
    s_cbranch_scc1 L_go5
    s_waitcnt vmcnt(3)
    s_cmp_gt_u32 s29, 1
    s_cbranch_scc1 L_go5
    s_waitcnt vmcnt(2)
L_go5:
    buffer_load_dwordx4 v[68:71], v1, s[24:27], s39 offen offset:0 nt
    buffer_load_dwordx4 v[72:75], v1, s[24:27], s39 offen offset:128 nt
    buffer_load_dwordx4 v[76:79], v1, s[24:27], s39 offen offset:256 nt
    s_add_u32 s40, s40, 1
    s_and_b32 s43, s40, 15
    s_cselect_b32 s43, s68, s69
    s_add_u32 s47, s47, s43
    s_add_u32 s46, s46, 8
    s_and_b32 s46, s46, 63
    s_mul_i32 s43, s46, 3072
    s_add_u32 s39, s47, s43
    s_waitcnt vmcnt(9)
    v_sub_f32 v10, v2, v4
    ds_read_b32 v2, v6 offset:512
    v_mul_f32 v10, s42, v10
    v_exp_f32 v10, v10
    s_nop 0
    v_cvt_pk_bf16_f32 v10, 0, v10
    v_lshrrev_b32 v11, 16, v10
    v_add_f32 v5, v5, v10
    v_dot2c_f32_bf16 v28, v80, v11
    v_dot2c_f32_bf16 v29, v80, v10
    v_dot2c_f32_bf16 v30, v81, v11
    v_dot2c_f32_bf16 v31, v81, v10
    v_dot2c_f32_bf16 v32, v82, v11
    v_dot2c_f32_bf16 v33, v82, v10
    v_dot2c_f32_bf16 v34, v83, v11
    v_dot2c_f32_bf16 v35, v83, v10
    v_dot2c_f32_bf16 v36, v84, v11
    v_dot2c_f32_bf16 v37, v84, v10
    v_dot2c_f32_bf16 v38, v85, v11
    v_dot2c_f32_bf16 v39, v85, v10
    v_dot2c_f32_bf16 v40, v86, v11
    v_dot2c_f32_bf16 v41, v86, v10
    v_dot2c_f32_bf16 v42, v87, v11
    v_dot2c_f32_bf16 v43, v87, v10
    v_dot2c_f32_bf16 v44, v88, v11
    v_dot2c_f32_bf16 v45, v88, v10
    v_dot2c_f32_bf16 v46, v89, v11
    v_dot2c_f32_bf16 v47, v89, v10
    v_dot2c_f32_bf16 v48, v90, v11
    v_dot2c_f32_bf16 v49, v90, v10
    v_dot2c_f32_bf16 v50, v91, v11
    v_dot2c_f32_bf16 v51, v91, v10
    s_waitcnt lgkmcnt(0)
    s_add_u32 s28, s28, s71
    s_lshr_b32 s29, s28, 8
    s_and_b32 s28, s28, 255
    s_waitcnt vmcnt(6)
    s_cmp_gt_u32 s29, 2
    s_cbranch_scc1 L_go6
    s_waitcnt vmcnt(3)
    s_cmp_gt_u32 s29, 1
    s_cbranch_scc1 L_go6
    s_waitcnt vmcnt(2)
L_go6:
    buffer_load_dwordx4 v[80:83], v1, s[24:27], s39 offen offset:0 nt
    buffer_load_dwordx4 v[84:87], v1, s[24:27], s39 offen offset:128 nt
    buffer_load_dwordx4 v[88:91], v1, s[24:27], s39 offen offset:256 nt
    s_add_u32 s40, s40, 1
    s_and_b32 s43, s40, 15
    s_cselect_b32 s43, s68, s69
    s_add_u32 s47, s47, s43
    s_add_u32 s46, s46, 8
    s_and_b32 s46, s46, 63
    s_mul_i32 s43, s46, 3072
    s_add_u32 s39, s47, s43
    s_waitcnt vmcnt(9)
    v_sub_f32 v10, v2, v4
    ds_read_b32 v2, v6 offset:768
    v_mul_f32 v10, s42, v10
    v_exp_f32 v10, v10
    s_nop 0
    v_cvt_pk_bf16_f32 v10, 0, v10
    v_lshrrev_b32 v11, 16, v10
    v_add_f32 v5, v5, v10
    v_dot2c_f32_bf16 v28, v92, v11
    v_dot2c_f32_bf16 v29, v92, v10
    v_dot2c_f32_bf16 v30, v93, v11
    v_dot2c_f32_bf16 v31, v93, v10
    v_dot2c_f32_bf16 v32, v94, v11
    v_dot2c_f32_bf16 v33, v94, v10
    v_dot2c_f32_bf16 v34, v95, v11
    v_dot2c_f32_bf16 v35, v95, v10
    v_dot2c_f32_bf16 v36, v96, v11
    v_dot2c_f32_bf16 v37, v96, v10
    v_dot2c_f32_bf16 v38, v97, v11
    v_dot2c_f32_bf16 v39, v97, v10
    v_dot2c_f32_bf16 v40, v98, v11
    v_dot2c_f32_bf16 v41, v98, v10
    v_dot2c_f32_bf16 v42, v99, v11
    v_dot2c_f32_bf16 v43, v99, v10
    v_dot2c_f32_bf16 v44, v100, v11
    v_dot2c_f32_bf16 v45, v100, v10
    v_dot2c_f32_bf16 v46, v101, v11
    v_dot2c_f32_bf16 v47, v101, v10
    v_dot2c_f32_bf16 v48, v102, v11
    v_dot2c_f32_bf16 v49, v102, v10
    v_dot2c_f32_bf16 v50, v103, v11
    v_dot2c_f32_bf16 v51, v103, v10
    s_waitcnt lgkmcnt(0)
    s_add_u32 s28, s28, s71
    s_lshr_b32 s29, s28, 8
    s_and_b32 s28, s28, 255
    s_waitcnt vmcnt(6)
    s_cmp_gt_u32 s29, 2
    s_cbranch_scc1 L_go7
    s_waitcnt vmcnt(3)
    s_cmp_gt_u32 s29, 1
    s_cbranch_scc1 L_go7
    s_waitcnt vmcnt(2)
L_go7:
    buffer_load_dwordx4 v[92:95], v1, s[24:27], s39 offen offset:0 nt
    buffer_load_dwordx4 v[96:99], v1, s[24:27], s39 offen offset:128 nt
    buffer_load_dwordx4 v[100:103], v1, s[24:27], s39 offen offset:256 nt
    s_add_u32 s40, s40, 1
    s_and_b32 s43, s40, 15
    s_cselect_b32 s43, s68, s69
    s_add_u32 s47, s47, s43
    s_add_u32 s46, s46, 8
    s_and_b32 s46, s46, 63
    s_mul_i32 s43, s46, 3072
    s_add_u32 s39, s47, s43
    s_waitcnt vmcnt(9)
    v_sub_f32 v10, v2, v4
    ds_read_b32 v2, v6 offset:1024
    v_mul_f32 v10, s42, v10
    v_exp_f32 v10, v10
    s_nop 0
    v_cvt_pk_bf16_f32 v10, 0, v10
    v_lshrrev_b32 v11, 16, v10
    v_add_f32 v5, v5, v10
    v_dot2c_f32_bf16 v28, v104, v11
    v_dot2c_f32_bf16 v29, v104, v10
    v_dot2c_f32_bf16 v30, v105, v11
    v_dot2c_f32_bf16 v31, v105, v10
    v_dot2c_f32_bf16 v32, v106, v11
    v_dot2c_f32_bf16 v33, v106, v10
    v_dot2c_f32_bf16 v34, v107, v11
    v_dot2c_f32_bf16 v35, v107, v10
    v_dot2c_f32_bf16 v36, v108, v11
    v_dot2c_f32_bf16 v37, v108, v10
    v_dot2c_f32_bf16 v38, v109, v11
    v_dot2c_f32_bf16 v39, v109, v10
    v_dot2c_f32_bf16 v40, v110, v11
    v_dot2c_f32_bf16 v41, v110, v10
    v_dot2c_f32_bf16 v42, v111, v11
    v_dot2c_f32_bf16 v43, v111, v10
    v_dot2c_f32_bf16 v44, v112, v11
    v_dot2c_f32_bf16 v45, v112, v10
    v_dot2c_f32_bf16 v46, v113, v11
    v_dot2c_f32_bf16 v47, v113, v10
    v_dot2c_f32_bf16 v48, v114, v11
    v_dot2c_f32_bf16 v49, v114, v10
    v_dot2c_f32_bf16 v50, v115, v11
    v_dot2c_f32_bf16 v51, v115, v10
    s_waitcnt lgkmcnt(0)
    s_add_u32 s28, s28, s71
    s_lshr_b32 s29, s28, 8
    s_and_b32 s28, s28, 255
    s_waitcnt vmcnt(6)
    s_cmp_gt_u32 s29, 2
    s_cbranch_scc1 L_go8
    s_waitcnt vmcnt(3)
    s_cmp_gt_u32 s29, 1
    s_cbranch_scc1 L_go8
    s_waitcnt vmcnt(2)
L_go8:
    buffer_load_dwordx4 v[104:107], v1, s[24:27], s39 offen offset:0 nt
    buffer_load_dwordx4 v[108:111], v1, s[24:27], s39 offen offset:128 nt
    buffer_load_dwordx4 v[112:115], v1, s[24:27], s39 offen offset:256 nt
    s_add_u32 s40, s40, 1
    s_and_b32 s43, s40, 15
    s_cselect_b32 s43, s68, s69
    s_add_u32 s47, s47, s43
    s_add_u32 s46, s46, 8
    s_and_b32 s46, s46, 63
    s_mul_i32 s43, s46, 3072
    s_add_u32 s39, s47, s43
    v_add_u32 v6, 1024, v6
    s_add_u32 s41, s41, 4
    s_memrealtime s[32:33]
    ds_read_b96 v[52:54], v55 offset:16
    s_add_u32 s30, s30, 4
    s_and_b32 s43, s41, 7
    s_xor_b32 s29, s38, 1
    s_or_b32 s43, s43, s29
    s_waitcnt lgkmcnt(0)
    s_cbranch_scc1 L_nopt9
    s_lshr_b32 s43, s30, 1
    s_or_b32 s29, s32, 1
    v_mov_b32 v3, s43
    v_mov_b32 v15, s29
    ds_write_b32 v3, v15 offset:60
L_nopt9:
    v_readfirstlane_b32 s29, v52
    v_readfirstlane_b32 s43, v53
    v_readfirstlane_b32 s31, v54
    s_cmp_eq_u32 s29, 0
    s_cbranch_scc1 L_noctl9
    s_sub_i32 s29, s30, s29
    s_sub_i32 s43, s32, s43
    s_mul_i32 s31, s31, s29
    s_ashr_i32 s31, s31, 4
    s_sub_i32 s43, s43, s31
    s_max_i32 s43, s43, -1000
    s_min_i32 s43, s43, 1000
    s_mul_i32 s43, s43, 426
    s_ashr_i32 s43, s43, 8
    s_add_i32 s43, s43, 499
    s_max_i32 s43, s43, 256
    s_min_i32 s71, s43, 768
L_noctl9:
    s_and_b32 s43, s41, 15
    s_cbranch_scc0 L_vround
    s_cmp_lg_u32 s41, 56
    s_cbranch_scc1 L_vloop
    s_branch L_vdone
L_vround:
    s_cmp_eq_u32 s41, 32
    s_cbranch_scc1 L_vh32
    s_cmp_eq_u32 s41, 48
    s_cbranch_scc1 L_vh48
L_vh16:
    s_nop 2
    v_add_f32_dpp v5, v5, v5 row_ror:8 row_mask:0xf bank_mask:0xf
    v_mov_b32 v15, v5
    s_nop 1
    v_permlane16_swap_b32 v5, v15
    v_add_f32 v5, v5, v15
    v_mov_b32 v15, v5
    s_nop 1
    v_permlane32_swap_b32 v5, v15
    v_add_f32 v5, v5, v15
    v_cndmask_b32 v27, v5, v4, s[44:45]
    v_permlane32_swap_b32 v28, v32
    v_permlane32_swap_b32 v29, v33
    v_permlane32_swap_b32 v30, v34
    v_permlane32_swap_b32 v31, v35
    v_permlane32_swap_b32 v36, v40
    v_permlane32_swap_b32 v37, v41
    v_permlane32_swap_b32 v38, v42
    v_permlane32_swap_b32 v39, v43
    v_permlane32_swap_b32 v44, v48
    v_permlane32_swap_b32 v45, v49
    v_permlane32_swap_b32 v46, v50
    v_permlane32_swap_b32 v47, v51
    v_add_f32 v28, v28, v32
    v_add_f32 v29, v29, v33
    v_add_f32 v30, v30, v34
    v_add_f32 v31, v31, v35
    v_add_f32 v36, v36, v40
    v_add_f32 v37, v37, v41
    v_add_f32 v38, v38, v42
    v_add_f32 v39, v39, v43
    v_add_f32 v44, v44, v48
    v_add_f32 v45, v45, v49
    v_add_f32 v46, v46, v50
    v_add_f32 v47, v47, v51
    v_permlane16_swap_b32 v28, v30
    v_permlane16_swap_b32 v29, v31
    v_permlane16_swap_b32 v36, v38
    v_permlane16_swap_b32 v37, v39
    v_permlane16_swap_b32 v44, v46
    v_permlane16_swap_b32 v45, v47
    v_add_f32 v28, v28, v30
    v_add_f32 v29, v29, v31
    v_add_f32 v36, v36, v38
    v_add_f32 v37, v37, v39
    v_add_f32 v44, v44, v46
    v_add_f32 v45, v45, v47
    v_add_f32_dpp v24, v28, v28 row_ror:8 row_mask:0xf bank_mask:0x3
    v_add_f32_dpp v25, v36, v36 row_ror:8 row_mask:0xf bank_mask:0x3
    v_add_f32_dpp v26, v44, v44 row_ror:8 row_mask:0xf bank_mask:0x3
    v_add_f32_dpp v24, v29, v29 row_ror:8 row_mask:0xf bank_mask:0xc
    v_add_f32_dpp v25, v37, v37 row_ror:8 row_mask:0xf bank_mask:0xc
    v_add_f32_dpp v26, v45, v45 row_ror:8 row_mask:0xf bank_mask:0xc
    ds_write_b128 v19, v[24:27]
    v_add_u32 v19, 4096, v19
    v_mov_b32 v5, 0
    v_mov_b32 v28, 0
    v_mov_b32 v29, 0
    v_mov_b32 v30, 0
    v_mov_b32 v31, 0
    v_mov_b32 v32, 0
    v_mov_b32 v33, 0
    v_mov_b32 v34, 0
    v_mov_b32 v35, 0
    v_mov_b32 v36, 0
    v_mov_b32 v37, 0
    v_mov_b32 v38, 0
    v_mov_b32 v39, 0
    v_mov_b32 v40, 0
    v_mov_b32 v41, 0
    v_mov_b32 v42, 0
    v_mov_b32 v43, 0
    v_mov_b32 v44, 0
    v_mov_b32 v45, 0
    v_mov_b32 v46, 0
    v_mov_b32 v47, 0
    v_mov_b32 v48, 0
    v_mov_b32 v49, 0
    v_mov_b32 v50, 0
    v_mov_b32 v51, 0
    v_mov_b32 v4, s73
    s_nop 1
    s_branch L_vloop
L_vh32:
    s_nop 2
    v_add_f32_dpp v5, v5, v5 row_ror:8 row_mask:0xf bank_mask:0xf
    v_mov_b32 v15, v5
    s_nop 1
    v_permlane16_swap_b32 v5, v15
    v_add_f32 v5, v5, v15
    v_mov_b32 v15, v5
    s_nop 1
    v_permlane32_swap_b32 v5, v15
    v_add_f32 v5, v5, v15
    v_cndmask_b32 v27, v5, v4, s[44:45]
    v_permlane32_swap_b32 v28, v32
    v_permlane32_swap_b32 v29, v33
    v_permlane32_swap_b32 v30, v34
    v_permlane32_swap_b32 v31, v35
    v_permlane32_swap_b32 v36, v40
    v_permlane32_swap_b32 v37, v41
    v_permlane32_swap_b32 v38, v42
    v_permlane32_swap_b32 v39, v43
    v_permlane32_swap_b32 v44, v48
    v_permlane32_swap_b32 v45, v49
    v_permlane32_swap_b32 v46, v50
    v_permlane32_swap_b32 v47, v51
    v_add_f32 v28, v28, v32
    v_add_f32 v29, v29, v33
    v_add_f32 v30, v30, v34
    v_add_f32 v31, v31, v35
    v_add_f32 v36, v36, v40
    v_add_f32 v37, v37, v41
    v_add_f32 v38, v38, v42
    v_add_f32 v39, v39, v43
    v_add_f32 v44, v44, v48
    v_add_f32 v45, v45, v49
    v_add_f32 v46, v46, v50
    v_add_f32 v47, v47, v51
    v_permlane16_swap_b32 v28, v30
    v_permlane16_swap_b32 v29, v31
    v_permlane16_swap_b32 v36, v38
    v_permlane16_swap_b32 v37, v39
    v_permlane16_swap_b32 v44, v46
    v_permlane16_swap_b32 v45, v47
    v_add_f32 v28, v28, v30
    v_add_f32 v29, v29, v31
    v_add_f32 v36, v36, v38
    v_add_f32 v37, v37, v39
    v_add_f32 v44, v44, v46
    v_add_f32 v45, v45, v47
    v_add_f32_dpp v24, v28, v28 row_ror:8 row_mask:0xf bank_mask:0x3
    v_add_f32_dpp v25, v36, v36 row_ror:8 row_mask:0xf bank_mask:0x3
    v_add_f32_dpp v26, v44, v44 row_ror:8 row_mask:0xf bank_mask:0x3
    v_add_f32_dpp v24, v29, v29 row_ror:8 row_mask:0xf bank_mask:0xc
    v_add_f32_dpp v25, v37, v37 row_ror:8 row_mask:0xf bank_mask:0xc
    v_add_f32_dpp v26, v45, v45 row_ror:8 row_mask:0xf bank_mask:0xc
    ds_write_b128 v19, v[24:27]
    v_add_u32 v19, 4096, v19
    v_mov_b32 v5, 0
    v_mov_b32 v28, 0
    v_mov_b32 v29, 0
    v_mov_b32 v30, 0
    v_mov_b32 v31, 0
    v_mov_b32 v32, 0
    v_mov_b32 v33, 0
    v_mov_b32 v34, 0
    v_mov_b32 v35, 0
    v_mov_b32 v36, 0
    v_mov_b32 v37, 0
    v_mov_b32 v38, 0
    v_mov_b32 v39, 0
    v_mov_b32 v40, 0
    v_mov_b32 v41, 0
    v_mov_b32 v42, 0
    v_mov_b32 v43, 0
    v_mov_b32 v44, 0
    v_mov_b32 v45, 0
    v_mov_b32 v46, 0
    v_mov_b32 v47, 0
    v_mov_b32 v48, 0
    v_mov_b32 v49, 0
    v_mov_b32 v50, 0
    v_mov_b32 v51, 0
    v_mov_b32 v4, s74
    s_nop 1
    s_branch L_vloop
L_vh48:
    s_nop 2
    v_add_f32_dpp v5, v5, v5 row_ror:8 row_mask:0xf bank_mask:0xf
    v_mov_b32 v15, v5
    s_nop 1
    v_permlane16_swap_b32 v5, v15
    v_add_f32 v5, v5, v15
    v_mov_b32 v15, v5
    s_nop 1
    v_permlane32_swap_b32 v5, v15
    v_add_f32 v5, v5, v15
    v_cndmask_b32 v27, v5, v4, s[44:45]
    v_permlane32_swap_b32 v28, v32
    v_permlane32_swap_b32 v29, v33
    v_permlane32_swap_b32 v30, v34
    v_permlane32_swap_b32 v31, v35
    v_permlane32_swap_b32 v36, v40
    v_permlane32_swap_b32 v37, v41
    v_permlane32_swap_b32 v38, v42
    v_permlane32_swap_b32 v39, v43
    v_permlane32_swap_b32 v44, v48
    v_permlane32_swap_b32 v45, v49
    v_permlane32_swap_b32 v46, v50
    v_permlane32_swap_b32 v47, v51
    v_add_f32 v28, v28, v32
    v_add_f32 v29, v29, v33
    v_add_f32 v30, v30, v34
    v_add_f32 v31, v31, v35
    v_add_f32 v36, v36, v40
    v_add_f32 v37, v37, v41
    v_add_f32 v38, v38, v42
    v_add_f32 v39, v39, v43
    v_add_f32 v44, v44, v48
    v_add_f32 v45, v45, v49
    v_add_f32 v46, v46, v50
    v_add_f32 v47, v47, v51
    v_permlane16_swap_b32 v28, v30
    v_permlane16_swap_b32 v29, v31
    v_permlane16_swap_b32 v36, v38
    v_permlane16_swap_b32 v37, v39
    v_permlane16_swap_b32 v44, v46
    v_permlane16_swap_b32 v45, v47
    v_add_f32 v28, v28, v30
    v_add_f32 v29, v29, v31
    v_add_f32 v36, v36, v38
    v_add_f32 v37, v37, v39
    v_add_f32 v44, v44, v46
    v_add_f32 v45, v45, v47
    v_add_f32_dpp v24, v28, v28 row_ror:8 row_mask:0xf bank_mask:0x3
    v_add_f32_dpp v25, v36, v36 row_ror:8 row_mask:0xf bank_mask:0x3
    v_add_f32_dpp v26, v44, v44 row_ror:8 row_mask:0xf bank_mask:0x3
    v_add_f32_dpp v24, v29, v29 row_ror:8 row_mask:0xf bank_mask:0xc
    v_add_f32_dpp v25, v37, v37 row_ror:8 row_mask:0xf bank_mask:0xc
    v_add_f32_dpp v26, v45, v45 row_ror:8 row_mask:0xf bank_mask:0xc
    ds_write_b128 v19, v[24:27]
    v_add_u32 v19, 4096, v19
    v_mov_b32 v5, 0
    v_mov_b32 v28, 0
    v_mov_b32 v29, 0
    v_mov_b32 v30, 0
    v_mov_b32 v31, 0
    v_mov_b32 v32, 0
    v_mov_b32 v33, 0
    v_mov_b32 v34, 0
    v_mov_b32 v35, 0
    v_mov_b32 v36, 0
    v_mov_b32 v37, 0
    v_mov_b32 v38, 0
    v_mov_b32 v39, 0
    v_mov_b32 v40, 0
    v_mov_b32 v41, 0
    v_mov_b32 v42, 0
    v_mov_b32 v43, 0
    v_mov_b32 v44, 0
    v_mov_b32 v45, 0
    v_mov_b32 v46, 0
    v_mov_b32 v47, 0
    v_mov_b32 v48, 0
    v_mov_b32 v49, 0
    v_mov_b32 v50, 0
    v_mov_b32 v51, 0
    v_mov_b32 v4, s75
    s_nop 1
    s_branch L_vloop
L_vdone:
    s_nop 2
    s_waitcnt vmcnt(9)
    v_sub_f32 v10, v2, v4
    ds_read_b32 v2, v6 offset:256
    v_mul_f32 v10, s42, v10
    v_exp_f32 v10, v10
    s_nop 0
    v_cvt_pk_bf16_f32 v10, 0, v10
    v_lshrrev_b32 v11, 16, v10
    v_add_f32 v5, v5, v10
    v_dot2c_f32_bf16 v28, v68, v11
    v_dot2c_f32_bf16 v29, v68, v10
    v_dot2c_f32_bf16 v30, v69, v11
    v_dot2c_f32_bf16 v31, v69, v10
    v_dot2c_f32_bf16 v32, v70, v11
    v_dot2c_f32_bf16 v33, v70, v10
    v_dot2c_f32_bf16 v34, v71, v11
    v_dot2c_f32_bf16 v35, v71, v10
    v_dot2c_f32_bf16 v36, v72, v11
    v_dot2c_f32_bf16 v37, v72, v10
    v_dot2c_f32_bf16 v38, v73, v11
    v_dot2c_f32_bf16 v39, v73, v10
    v_dot2c_f32_bf16 v40, v74, v11
    v_dot2c_f32_bf16 v41, v74, v10
    v_dot2c_f32_bf16 v42, v75, v11
    v_dot2c_f32_bf16 v43, v75, v10
    v_dot2c_f32_bf16 v44, v76, v11
    v_dot2c_f32_bf16 v45, v76, v10
    v_dot2c_f32_bf16 v46, v77, v11
    v_dot2c_f32_bf16 v47, v77, v10
    v_dot2c_f32_bf16 v48, v78, v11
    v_dot2c_f32_bf16 v49, v78, v10
    v_dot2c_f32_bf16 v50, v79, v11
    v_dot2c_f32_bf16 v51, v79, v10
    s_waitcnt lgkmcnt(0)
    s_add_u32 s28, s28, s71
    s_lshr_b32 s29, s28, 8
    s_and_b32 s28, s28, 255
    s_waitcnt vmcnt(6)
    s_cmp_gt_u32 s29, 2
    s_cbranch_scc1 L_go10
    s_waitcnt vmcnt(3)
    s_cmp_gt_u32 s29, 1
    s_cbranch_scc1 L_go10
    s_waitcnt vmcnt(2)
L_go10:
    buffer_load_dwordx4 v[68:71], v1, s[24:27], s39 offen offset:0 nt
    buffer_load_dwordx4 v[72:75], v1, s[24:27], s39 offen offset:128 nt
    buffer_load_dwordx4 v[76:79], v1, s[24:27], s39 offen offset:256 nt
    s_add_u32 s40, s40, 1
    s_and_b32 s43, s40, 15
    s_cselect_b32 s43, s68, s69
    s_add_u32 s47, s47, s43
    s_add_u32 s46, s46, 8
    s_and_b32 s46, s46, 63
    s_mul_i32 s43, s46, 3072
    s_add_u32 s39, s47, s43
    s_waitcnt vmcnt(9)
    v_sub_f32 v10, v2, v4
    ds_read_b32 v2, v6 offset:512
    v_mul_f32 v10, s42, v10
    v_exp_f32 v10, v10
    s_nop 0
    v_cvt_pk_bf16_f32 v10, 0, v10
    v_lshrrev_b32 v11, 16, v10
    v_add_f32 v5, v5, v10
    v_dot2c_f32_bf16 v28, v80, v11
    v_dot2c_f32_bf16 v29, v80, v10
    v_dot2c_f32_bf16 v30, v81, v11
    v_dot2c_f32_bf16 v31, v81, v10
    v_dot2c_f32_bf16 v32, v82, v11
    v_dot2c_f32_bf16 v33, v82, v10
    v_dot2c_f32_bf16 v34, v83, v11
    v_dot2c_f32_bf16 v35, v83, v10
    v_dot2c_f32_bf16 v36, v84, v11
    v_dot2c_f32_bf16 v37, v84, v10
    v_dot2c_f32_bf16 v38, v85, v11
    v_dot2c_f32_bf16 v39, v85, v10
    v_dot2c_f32_bf16 v40, v86, v11
    v_dot2c_f32_bf16 v41, v86, v10
    v_dot2c_f32_bf16 v42, v87, v11
    v_dot2c_f32_bf16 v43, v87, v10
    v_dot2c_f32_bf16 v44, v88, v11
    v_dot2c_f32_bf16 v45, v88, v10
    v_dot2c_f32_bf16 v46, v89, v11
    v_dot2c_f32_bf16 v47, v89, v10
    v_dot2c_f32_bf16 v48, v90, v11
    v_dot2c_f32_bf16 v49, v90, v10
    v_dot2c_f32_bf16 v50, v91, v11
    v_dot2c_f32_bf16 v51, v91, v10
    s_waitcnt lgkmcnt(0)
    s_add_u32 s28, s28, s71
    s_lshr_b32 s29, s28, 8
    s_and_b32 s28, s28, 255
    s_waitcnt vmcnt(6)
    s_cmp_gt_u32 s29, 2
    s_cbranch_scc1 L_go11
    s_waitcnt vmcnt(3)
    s_cmp_gt_u32 s29, 1
    s_cbranch_scc1 L_go11
    s_waitcnt vmcnt(2)
L_go11:
    buffer_load_dwordx4 v[80:83], v1, s[24:27], s39 offen offset:0 nt
    buffer_load_dwordx4 v[84:87], v1, s[24:27], s39 offen offset:128 nt
    buffer_load_dwordx4 v[88:91], v1, s[24:27], s39 offen offset:256 nt
    s_add_u32 s40, s40, 1
    s_and_b32 s43, s40, 15
    s_cselect_b32 s43, s68, s69
    s_add_u32 s47, s47, s43
    s_add_u32 s46, s46, 8
    s_and_b32 s46, s46, 63
    s_mul_i32 s43, s46, 3072
    s_add_u32 s39, s47, s43
    s_waitcnt vmcnt(9)
    v_sub_f32 v10, v2, v4
    ds_read_b32 v2, v6 offset:768
    v_mul_f32 v10, s42, v10
    v_exp_f32 v10, v10
    s_nop 0
    v_cvt_pk_bf16_f32 v10, 0, v10
    v_lshrrev_b32 v11, 16, v10
    v_add_f32 v5, v5, v10
    v_dot2c_f32_bf16 v28, v92, v11
    v_dot2c_f32_bf16 v29, v92, v10
    v_dot2c_f32_bf16 v30, v93, v11
    v_dot2c_f32_bf16 v31, v93, v10
    v_dot2c_f32_bf16 v32, v94, v11
    v_dot2c_f32_bf16 v33, v94, v10
    v_dot2c_f32_bf16 v34, v95, v11
    v_dot2c_f32_bf16 v35, v95, v10
    v_dot2c_f32_bf16 v36, v96, v11
    v_dot2c_f32_bf16 v37, v96, v10
    v_dot2c_f32_bf16 v38, v97, v11
    v_dot2c_f32_bf16 v39, v97, v10
    v_dot2c_f32_bf16 v40, v98, v11
    v_dot2c_f32_bf16 v41, v98, v10
    v_dot2c_f32_bf16 v42, v99, v11
    v_dot2c_f32_bf16 v43, v99, v10
    v_dot2c_f32_bf16 v44, v100, v11
    v_dot2c_f32_bf16 v45, v100, v10
    v_dot2c_f32_bf16 v46, v101, v11
    v_dot2c_f32_bf16 v47, v101, v10
    v_dot2c_f32_bf16 v48, v102, v11
    v_dot2c_f32_bf16 v49, v102, v10
    v_dot2c_f32_bf16 v50, v103, v11
    v_dot2c_f32_bf16 v51, v103, v10
    s_waitcnt lgkmcnt(0)
    buffer_load_dwordx4 v[92:95], v1, s[24:27], s39 offen offset:0 nt
    buffer_load_dwordx4 v[96:99], v1, s[24:27], s39 offen offset:128 nt
    buffer_load_dwordx4 v[100:103], v1, s[24:27], s39 offen offset:256 nt
    s_add_u32 s40, s40, 1
    s_and_b32 s43, s40, 15
    s_cselect_b32 s43, s68, s69
    s_add_u32 s47, s47, s43
    s_add_u32 s46, s46, 8
    s_and_b32 s46, s46, 63
    s_mul_i32 s43, s46, 3072
    s_add_u32 s39, s47, s43
    s_waitcnt vmcnt(9)
    v_sub_f32 v10, v2, v4
    ds_read_b32 v2, v6 offset:1024
    v_mul_f32 v10, s42, v10
    v_exp_f32 v10, v10
    s_nop 0
    v_cvt_pk_bf16_f32 v10, 0, v10
    v_lshrrev_b32 v11, 16, v10
    v_add_f32 v5, v5, v10
    v_dot2c_f32_bf16 v28, v104, v11
    v_dot2c_f32_bf16 v29, v104, v10
    v_dot2c_f32_bf16 v30, v105, v11
    v_dot2c_f32_bf16 v31, v105, v10
    v_dot2c_f32_bf16 v32, v106, v11
    v_dot2c_f32_bf16 v33, v106, v10
    v_dot2c_f32_bf16 v34, v107, v11
    v_dot2c_f32_bf16 v35, v107, v10
    v_dot2c_f32_bf16 v36, v108, v11
    v_dot2c_f32_bf16 v37, v108, v10
    v_dot2c_f32_bf16 v38, v109, v11
    v_dot2c_f32_bf16 v39, v109, v10
    v_dot2c_f32_bf16 v40, v110, v11
    v_dot2c_f32_bf16 v41, v110, v10
    v_dot2c_f32_bf16 v42, v111, v11
    v_dot2c_f32_bf16 v43, v111, v10
    v_dot2c_f32_bf16 v44, v112, v11
    v_dot2c_f32_bf16 v45, v112, v10
    v_dot2c_f32_bf16 v46, v113, v11
    v_dot2c_f32_bf16 v47, v113, v10
    v_dot2c_f32_bf16 v48, v114, v11
    v_dot2c_f32_bf16 v49, v114, v10
    v_dot2c_f32_bf16 v50, v115, v11
    v_dot2c_f32_bf16 v51, v115, v10
    s_waitcnt lgkmcnt(0)
    buffer_load_dwordx4 v[104:107], v1, s[24:27], s39 offen offset:0 nt
    buffer_load_dwordx4 v[108:111], v1, s[24:27], s39 offen offset:128 nt
    buffer_load_dwordx4 v[112:115], v1, s[24:27], s39 offen offset:256 nt
    s_add_u32 s40, s40, 1
    s_and_b32 s43, s40, 15
    s_cselect_b32 s43, s68, s69
    s_add_u32 s47, s47, s43
    s_add_u32 s46, s46, 8
    s_and_b32 s46, s46, 63
    s_mul_i32 s43, s46, 3072
    s_add_u32 s39, s47, s43
    v_add_u32 v6, 1024, v6
    s_mov_b32 s52, s16
    s_mov_b32 s53, s17
    s_mov_b32 s54, 24576
    s_mov_b32 s55, 0x00020000
    s_mov_b32 s48, s20
    s_mov_b32 s49, s21
    s_mov_b32 s50, 1091584
    s_mov_b32 s51, 0x00020000
    s_mul_i32 s64, s38, 16
    s_add_u32 s64, s64, s36
    s_mul_i32 s76, s64, 16384
    s_add_u32 s77, s76, 4096
    s_add_u32 s78, s76, 8192
    s_add_u32 s79, s76, 12288
    s_lshl_b32 s43, s37, 10
    s_add_u32 s65, s76, s43
    v_lshlrev_b32 v21, 10, v8
    s_lshl_b32 s67, s36, 9
    s_add_u32 s67, s67, 1083392
    s_lshl_b32 s43, s38, 7
    s_add_u32 s67, s67, s43
    s_mul_i32 s66, s64, 384
    v_lshlrev_b32 v17, 4, v8
    v_lshrrev_b32 v18, 3, v8
    v_lshl_add_u32 v18, v18, 1, v20
    v_sub_f32 v10, v2, v4
    ds_read_b32 v2, v6 offset:256
    v_mul_f32 v10, s42, v10
    v_exp_f32 v10, v10
    s_nop 0
    v_cvt_pk_bf16_f32 v10, 0, v10
    v_lshrrev_b32 v11, 16, v10
    v_add_f32 v5, v5, v10
    s_waitcnt vmcnt(9)
    v_dot2c_f32_bf16 v28, v68, v11
    v_dot2c_f32_bf16 v29, v68, v10
    v_dot2c_f32_bf16 v30, v69, v11
    v_dot2c_f32_bf16 v31, v69, v10
    v_dot2c_f32_bf16 v32, v70, v11
    v_dot2c_f32_bf16 v33, v70, v10
    v_dot2c_f32_bf16 v34, v71, v11
    v_dot2c_f32_bf16 v35, v71, v10
    v_dot2c_f32_bf16 v36, v72, v11
    v_dot2c_f32_bf16 v37, v72, v10
    v_dot2c_f32_bf16 v38, v73, v11
    v_dot2c_f32_bf16 v39, v73, v10
    v_dot2c_f32_bf16 v40, v74, v11
    v_dot2c_f32_bf16 v41, v74, v10
    v_dot2c_f32_bf16 v42, v75, v11
    v_dot2c_f32_bf16 v43, v75, v10
    v_dot2c_f32_bf16 v44, v76, v11
    v_dot2c_f32_bf16 v45, v76, v10
    v_dot2c_f32_bf16 v46, v77, v11
    v_dot2c_f32_bf16 v47, v77, v10
    v_dot2c_f32_bf16 v48, v78, v11
    v_dot2c_f32_bf16 v49, v78, v10
    v_dot2c_f32_bf16 v50, v79, v11
    v_dot2c_f32_bf16 v51, v79, v10
    s_waitcnt lgkmcnt(0)
    v_sub_f32 v10, v2, v4
    ds_read_b32 v2, v6 offset:512
    v_mul_f32 v10, s42, v10
    v_exp_f32 v10, v10
    s_nop 0
    v_cvt_pk_bf16_f32 v10, 0, v10
    v_lshrrev_b32 v11, 16, v10
    v_add_f32 v5, v5, v10
    s_waitcnt vmcnt(6)
    v_dot2c_f32_bf16 v28, v80, v11
    v_dot2c_f32_bf16 v29, v80, v10
    v_dot2c_f32_bf16 v30, v81, v11
    v_dot2c_f32_bf16 v31, v81, v10
    v_dot2c_f32_bf16 v32, v82, v11
    v_dot2c_f32_bf16 v33, v82, v10
    v_dot2c_f32_bf16 v34, v83, v11
    v_dot2c_f32_bf16 v35, v83, v10
    v_dot2c_f32_bf16 v36, v84, v11
    v_dot2c_f32_bf16 v37, v84, v10
    v_dot2c_f32_bf16 v38, v85, v11
    v_dot2c_f32_bf16 v39, v85, v10
    v_dot2c_f32_bf16 v40, v86, v11
    v_dot2c_f32_bf16 v41, v86, v10
    v_dot2c_f32_bf16 v42, v87, v11
    v_dot2c_f32_bf16 v43, v87, v10
    v_dot2c_f32_bf16 v44, v88, v11
    v_dot2c_f32_bf16 v45, v88, v10
    v_dot2c_f32_bf16 v46, v89, v11
    v_dot2c_f32_bf16 v47, v89, v10
    v_dot2c_f32_bf16 v48, v90, v11
    v_dot2c_f32_bf16 v49, v90, v10
    v_dot2c_f32_bf16 v50, v91, v11
    v_dot2c_f32_bf16 v51, v91, v10
    s_waitcnt lgkmcnt(0)
    v_sub_f32 v10, v2, v4
    ds_read_b32 v2, v6 offset:768
    v_mul_f32 v10, s42, v10
    v_exp_f32 v10, v10
    s_nop 0
    v_cvt_pk_bf16_f32 v10, 0, v10
    v_lshrrev_b32 v11, 16, v10
    v_add_f32 v5, v5, v10
    s_waitcnt vmcnt(3)
    v_dot2c_f32_bf16 v28, v92, v11
    v_dot2c_f32_bf16 v29, v92, v10
    v_dot2c_f32_bf16 v30, v93, v11
    v_dot2c_f32_bf16 v31, v93, v10
    v_dot2c_f32_bf16 v32, v94, v11
    v_dot2c_f32_bf16 v33, v94, v10
    v_dot2c_f32_bf16 v34, v95, v11
    v_dot2c_f32_bf16 v35, v95, v10
    v_dot2c_f32_bf16 v36, v96, v11
    v_dot2c_f32_bf16 v37, v96, v10
    v_dot2c_f32_bf16 v38, v97, v11
    v_dot2c_f32_bf16 v39, v97, v10
    v_dot2c_f32_bf16 v40, v98, v11
    v_dot2c_f32_bf16 v41, v98, v10
    v_dot2c_f32_bf16 v42, v99, v11
    v_dot2c_f32_bf16 v43, v99, v10
    v_dot2c_f32_bf16 v44, v100, v11
    v_dot2c_f32_bf16 v45, v100, v10
    v_dot2c_f32_bf16 v46, v101, v11
    v_dot2c_f32_bf16 v47, v101, v10
    v_dot2c_f32_bf16 v48, v102, v11
    v_dot2c_f32_bf16 v49, v102, v10
    v_dot2c_f32_bf16 v50, v103, v11
    v_dot2c_f32_bf16 v51, v103, v10
    s_waitcnt lgkmcnt(0)
    v_sub_f32 v10, v2, v4
    ds_read_b32 v2, v6 offset:1024
    v_mul_f32 v10, s42, v10
    v_exp_f32 v10, v10
    s_nop 0
    v_cvt_pk_bf16_f32 v10, 0, v10
    v_lshrrev_b32 v11, 16, v10
    v_add_f32 v5, v5, v10
    s_nop 1
    v_add_f32_dpp v5, v5, v5 row_ror:8 row_mask:0xf bank_mask:0xf
    v_mov_b32 v15, v5
    s_nop 1
    v_permlane16_swap_b32 v5, v15
    v_add_f32 v5, v5, v15
    v_mov_b32 v15, v5
    s_nop 1
    v_permlane32_swap_b32 v5, v15
    v_add_f32 v5, v5, v15
    v_cndmask_b32 v27, v5, v4, s[44:45]
    s_lshl_b32 s43, s38, 12
    s_add_u32 s43, s43, 67584
    v_add_u32 v3, s43, v17
    s_lshl_b32 s43, s38, 10
    s_add_u32 s43, s43, 83968
    v_add_u32 v6, s43, v17
    s_waitcnt vmcnt(0)
    v_dot2c_f32_bf16 v28, v104, v11
    v_dot2c_f32_bf16 v29, v104, v10
    v_dot2c_f32_bf16 v30, v105, v11
    v_dot2c_f32_bf16 v31, v105, v10
    v_dot2c_f32_bf16 v32, v106, v11
    v_dot2c_f32_bf16 v33, v106, v10
    v_dot2c_f32_bf16 v34, v107, v11
    v_dot2c_f32_bf16 v35, v107, v10
    v_dot2c_f32_bf16 v36, v108, v11
    v_dot2c_f32_bf16 v37, v108, v10
    v_dot2c_f32_bf16 v38, v109, v11
    v_dot2c_f32_bf16 v39, v109, v10
    v_dot2c_f32_bf16 v40, v110, v11
    v_dot2c_f32_bf16 v41, v110, v10
    v_dot2c_f32_bf16 v42, v111, v11
    v_dot2c_f32_bf16 v43, v111, v10
    v_dot2c_f32_bf16 v44, v112, v11
    v_dot2c_f32_bf16 v45, v112, v10
    v_dot2c_f32_bf16 v46, v113, v11
    v_dot2c_f32_bf16 v47, v113, v10
    v_dot2c_f32_bf16 v48, v114, v11
    v_dot2c_f32_bf16 v49, v114, v10
    v_dot2c_f32_bf16 v50, v115, v11
    v_dot2c_f32_bf16 v51, v115, v10
    s_waitcnt lgkmcnt(0)
    v_permlane32_swap_b32 v28, v32
    v_permlane32_swap_b32 v29, v33
    v_permlane32_swap_b32 v30, v34
    v_permlane32_swap_b32 v31, v35
    v_permlane32_swap_b32 v36, v40
    v_permlane32_swap_b32 v37, v41
    v_permlane32_swap_b32 v38, v42
    v_permlane32_swap_b32 v39, v43
    v_permlane32_swap_b32 v44, v48
    v_permlane32_swap_b32 v45, v49
    v_permlane32_swap_b32 v46, v50
    v_permlane32_swap_b32 v47, v51
    v_add_f32 v28, v28, v32
    v_add_f32 v29, v29, v33
    v_add_f32 v30, v30, v34
    v_add_f32 v31, v31, v35
    v_add_f32 v36, v36, v40
    v_add_f32 v37, v37, v41
    v_add_f32 v38, v38, v42
    v_add_f32 v39, v39, v43
    v_add_f32 v44, v44, v48
    v_add_f32 v45, v45, v49
    v_add_f32 v46, v46, v50
    v_add_f32 v47, v47, v51
    v_permlane16_swap_b32 v28, v30
    v_permlane16_swap_b32 v29, v31
    v_permlane16_swap_b32 v36, v38
    v_permlane16_swap_b32 v37, v39
    v_permlane16_swap_b32 v44, v46
    v_permlane16_swap_b32 v45, v47
    v_add_f32 v28, v28, v30
    v_add_f32 v29, v29, v31
    v_add_f32 v36, v36, v38
    v_add_f32 v37, v37, v39
    v_add_f32 v44, v44, v46
    v_add_f32 v45, v45, v47
    v_add_f32_dpp v24, v28, v28 row_ror:8 row_mask:0xf bank_mask:0x3
    v_add_f32_dpp v25, v36, v36 row_ror:8 row_mask:0xf bank_mask:0x3
    v_add_f32_dpp v26, v44, v44 row_ror:8 row_mask:0xf bank_mask:0x3
    v_add_f32_dpp v24, v29, v29 row_ror:8 row_mask:0xf bank_mask:0xc
    v_add_f32_dpp v25, v37, v37 row_ror:8 row_mask:0xf bank_mask:0xc
    v_add_f32_dpp v26, v45, v45 row_ror:8 row_mask:0xf bank_mask:0xc
    ds_write_b128 v19, v[24:27]
    s_mov_b32 s68, 0xfffff800
    s_waitcnt lgkmcnt(0)
    s_barrier
    ds_read_b128 v[120:123], v3 offset:0
    ds_read_b128 v[124:127], v3 offset:1024
    ds_read_b128 v[128:131], v3 offset:2048
    ds_read_b128 v[132:135], v3 offset:3072
    ds_read_b128 v[136:139], v6
    s_waitcnt lgkmcnt(0)
    v_max_f32 v12, v123, v127
    v_max3_f32 v12, v12, v131, v135
    v_max_f32 v12, v12, v139
    v_sub_f32 v28, v123, v12
    v_sub_f32 v29, v127, v12
    v_sub_f32 v30, v131, v12
    v_sub_f32 v31, v135, v12
    v_sub_f32 v32, v139, v12
    v_mul_f32 v28, s42, v28
    v_mul_f32 v29, s42, v29
    v_mul_f32 v30, s42, v30
    v_mul_f32 v31, s42, v31
    v_mul_f32 v32, s42, v32
    v_exp_f32 v28, v28
    v_exp_f32 v29, v29
    v_exp_f32 v30, v30
    v_exp_f32 v31, v31
    v_exp_f32 v32, v32
    v_mov_b32_dpp v28, v28 quad_perm:[1,1,3,3] row_mask:0xf bank_mask:0xf
    v_mov_b32_dpp v29, v29 quad_perm:[1,1,3,3] row_mask:0xf bank_mask:0xf
    v_mov_b32_dpp v30, v30 quad_perm:[1,1,3,3] row_mask:0xf bank_mask:0xf
    v_mov_b32_dpp v31, v31 quad_perm:[1,1,3,3] row_mask:0xf bank_mask:0xf
    v_mov_b32_dpp v32, v32 quad_perm:[1,1,3,3] row_mask:0xf bank_mask:0xf
    v_mul_f32 v24, v28, v120
    v_mul_f32 v25, v28, v121
    v_mul_f32 v26, v28, v122
    v_mul_f32 v27, v28, v123
    v_fmac_f32 v24, v29, v124
    v_fmac_f32 v25, v29, v125
    v_fmac_f32 v26, v29, v126
    v_fmac_f32 v27, v29, v127
    v_fmac_f32 v24, v30, v128
    v_fmac_f32 v25, v30, v129
    v_fmac_f32 v26, v30, v130
    v_fmac_f32 v27, v30, v131
    v_fmac_f32 v24, v31, v132
    v_fmac_f32 v25, v31, v133
    v_fmac_f32 v26, v31, v134
    v_fmac_f32 v27, v31, v135
    v_fmac_f32 v24, v32, v136
    v_fmac_f32 v25, v32, v137
    v_fmac_f32 v26, v32, v138
    v_fmac_f32 v27, v32, v139
    v_cndmask_b32 v27, v27, v12, s[44:45]
    buffer_store_dwordx4 v[24:27], v17, s[48:51], s65 offen sc1
    v_mov_b32 v15, 1
    s_mov_b64 exec, 1
    s_waitcnt vmcnt(0)
    buffer_atomic_add v15, v55, s[48:51], s67 offen sc0
    s_mov_b64 exec, -1
    buffer_load_dwordx4 v[120:123], v17, s[48:51], s65 offen sc1
    s_waitcnt vmcnt(1)
    v_readfirstlane_b32 s43, v15
L_got:
    s_nop 1
    s_cmp_lg_u32 s43, 15
    s_cbranch_scc1 L_fin
    s_mov_b64 exec, 0xffff
    buffer_load_dword v22, v21, s[48:51], s76 offen offset:28 sc1
    buffer_load_dword v23, v21, s[48:51], s76 offen offset:12 sc1
    s_mov_b64 exec, -1
    buffer_load_dwordx3 v[56:58], v17, s[48:51], s76 offen offset:0 sc1
    buffer_load_dwordx3 v[60:62], v17, s[48:51], s76 offen offset:1024 sc1
    buffer_load_dwordx3 v[64:66], v17, s[48:51], s76 offen offset:2048 sc1
    buffer_load_dwordx3 v[68:70], v17, s[48:51], s76 offen offset:3072 sc1
    buffer_load_dwordx3 v[72:74], v17, s[48:51], s77 offen offset:0 sc1
    buffer_load_dwordx3 v[76:78], v17, s[48:51], s77 offen offset:1024 sc1
    buffer_load_dwordx3 v[80:82], v17, s[48:51], s77 offen offset:2048 sc1
    buffer_load_dwordx3 v[84:86], v17, s[48:51], s77 offen offset:3072 sc1
    buffer_load_dwordx3 v[88:90], v17, s[48:51], s78 offen offset:0 sc1
    buffer_load_dwordx3 v[92:94], v17, s[48:51], s78 offen offset:1024 sc1
    buffer_load_dwordx3 v[96:98], v17, s[48:51], s78 offen offset:2048 sc1
    buffer_load_dwordx3 v[100:102], v17, s[48:51], s78 offen offset:3072 sc1
    buffer_load_dwordx3 v[104:106], v17, s[48:51], s79 offen offset:0 sc1
    buffer_load_dwordx3 v[108:110], v17, s[48:51], s79 offen offset:1024 sc1
    buffer_load_dwordx3 v[112:114], v17, s[48:51], s79 offen offset:2048 sc1
    buffer_load_dwordx3 v[116:118], v17, s[48:51], s79 offen offset:3072 sc1
    s_waitcnt vmcnt(17)
    v_max_f32_dpp v12, v22, v22 row_ror:8 row_mask:0xf bank_mask:0xf
    s_nop 1
    v_max_f32_dpp v12, v12, v12 row_ror:4 row_mask:0xf bank_mask:0xf
    s_nop 1
    v_max_f32_dpp v12, v12, v12 row_ror:2 row_mask:0xf bank_mask:0xf
    s_nop 1
    v_max_f32_dpp v12, v12, v12 row_ror:1 row_mask:0xf bank_mask:0xf
    v_sub_f32 v22, v22, v12
    v_mul_f32 v22, s42, v22
    v_exp_f32 v22, v22
    s_waitcnt vmcnt(16)
    v_mul_f32 v23, v23, v22
    v_readlane_b32 s80, v22, 0
    v_readlane_b32 s81, v22, 1
    v_add_f32_dpp v23, v23, v23 row_ror:8 row_mask:0xf bank_mask:0xf
    v_readlane_b32 s82, v22, 2
    v_readlane_b32 s83, v22, 3
    v_readlane_b32 s84, v22, 4
    v_add_f32_dpp v23, v23, v23 row_ror:4 row_mask:0xf bank_mask:0xf
    v_readlane_b32 s85, v22, 5
    v_readlane_b32 s86, v22, 6
    v_readlane_b32 s87, v22, 7
    v_add_f32_dpp v23, v23, v23 row_ror:2 row_mask:0xf bank_mask:0xf
    v_readlane_b32 s88, v22, 8
    v_readlane_b32 s89, v22, 9
    v_readlane_b32 s90, v22, 10
    v_add_f32_dpp v23, v23, v23 row_ror:1 row_mask:0xf bank_mask:0xf
    v_readlane_b32 s91, v22, 11
    v_readlane_b32 s92, v22, 12
    v_readlane_b32 s93, v22, 13
    v_readlane_b32 s94, v22, 14
    v_readlane_b32 s95, v22, 15
    v_rcp_f32 v23, v23
    s_waitcnt vmcnt(12)
    v_mul_f32 v24, s80, v56
    v_mul_f32 v25, s80, v57
    v_mul_f32 v26, s80, v58
    v_readfirstlane_b32 s43, v23
    v_fmac_f32 v24, s81, v60
    v_fmac_f32 v25, s81, v61
    v_fmac_f32 v26, s81, v62
    v_fmac_f32 v24, s82, v64
    v_fmac_f32 v25, s82, v65
    v_fmac_f32 v26, s82, v66
    v_fmac_f32 v24, s83, v68
    v_fmac_f32 v25, s83, v69
    v_fmac_f32 v26, s83, v70
    s_waitcnt vmcnt(8)
    v_fmac_f32 v24, s84, v72
    v_fmac_f32 v25, s84, v73
    v_fmac_f32 v26, s84, v74
    v_fmac_f32 v24, s85, v76
    v_fmac_f32 v25, s85, v77
    v_fmac_f32 v26, s85, v78
    v_fmac_f32 v24, s86, v80
    v_fmac_f32 v25, s86, v81
    v_fmac_f32 v26, s86, v82
    v_fmac_f32 v24, s87, v84
    v_fmac_f32 v25, s87, v85
    v_fmac_f32 v26, s87, v86
    s_waitcnt vmcnt(4)
    v_fmac_f32 v24, s88, v88
    v_fmac_f32 v25, s88, v89
    v_fmac_f32 v26, s88, v90
    v_fmac_f32 v24, s89, v92
    v_fmac_f32 v25, s89, v93
    v_fmac_f32 v26, s89, v94
    v_fmac_f32 v24, s90, v96
    v_fmac_f32 v25, s90, v97
    v_fmac_f32 v26, s90, v98
    v_fmac_f32 v24, s91, v100
    v_fmac_f32 v25, s91, v101
    v_fmac_f32 v26, s91, v102
    s_waitcnt vmcnt(0)
    v_fmac_f32 v24, s92, v104
    v_fmac_f32 v25, s92, v105
    v_fmac_f32 v26, s92, v106
    v_fmac_f32 v24, s93, v108
    v_fmac_f32 v25, s93, v109
    v_fmac_f32 v26, s93, v110
    v_fmac_f32 v24, s94, v112
    v_fmac_f32 v25, s94, v113
    v_fmac_f32 v26, s94, v114
    v_fmac_f32 v24, s95, v116
    v_fmac_f32 v25, s95, v117
    v_fmac_f32 v26, s95, v118
    v_mul_f32 v24, s43, v24
    v_mul_f32 v25, s43, v25
    v_mul_f32 v26, s43, v26
    v_cvt_pk_bf16_f32 v24, v24, v24
    v_cvt_pk_bf16_f32 v25, v25, v25
    v_cvt_pk_bf16_f32 v26, v26, v26
    buffer_store_short v24, v18, s[52:55], s66 offen offset:0 sc1
    buffer_store_short v25, v18, s[52:55], s66 offen offset:128 sc1
    buffer_store_short v26, v18, s[52:55], s66 offen offset:256 sc1
L_fin:
    s_endpgm
L_helper:
    s_load_dwordx16 s[4:19], s[0:1], 0
    v_lshlrev_b32 v17, 4, v8
    v_mov_b32 v55, 0
    s_waitcnt lgkmcnt(0)
    s_nop 2
    s_mul_i32 s43, s36, 384
    v_add_u32 v3, s43, v17
    s_mov_b64 exec, 0xffffff
    global_load_dwordx4 v[28:31], v3, s[4:5]
    v_add_u32 v3, 6144, v3
    global_load_dwordx4 v[32:35], v3, s[4:5]
    v_add_u32 v3, 6144, v3
    global_load_dwordx4 v[36:39], v3, s[4:5]
    v_add_u32 v3, 6144, v3
    global_load_dwordx4 v[40:43], v3, s[4:5]
    s_mov_b64 exec, -1
    s_load_dwordx2 s[20:21], s[0:1], 64
    s_memrealtime s[34:35]
    v_lshlrev_b32 v2, 2, v8
    ds_write_b32 v2, v55
    s_mov_b32 s44, 0xaaaaaaaa
    s_mov_b32 s45, 0xaaaaaaaa
    s_mov_b64 exec, 0xffffff
    s_waitcnt vmcnt(0)
    ds_write_b128 v17, v[28:31] offset:512
    ds_write_b128 v17, v[32:35] offset:896
    ds_write_b128 v17, v[36:39] offset:1280
    ds_write_b128 v17, v[40:43] offset:1664
    s_mov_b64 exec, -1
    s_waitcnt lgkmcnt(0)
    s_barrier
    s_mov_b32 s48, s20
    s_mov_b32 s49, s21
    s_mov_b32 s50, 1091584
    s_mov_b32 s51, 0x00020000
    v_mov_b32 v24, 0
    v_mov_b32 v25, 0
    v_mov_b32 v26, 0
    v_mov_b32 v4, 0xf149f2ca
    v_cndmask_b32 v27, v24, v4, s[44:45]
    v_add_u32 v19, 83968, v17
    s_cmp_eq_u32 s37, 0
    s_cbranch_scc1 L_tree
    ds_write_b128 v19, v[24:27] offset:0
    ds_write_b128 v19, v[24:27] offset:1024
    ds_write_b128 v19, v[24:27] offset:2048
    ds_write_b128 v19, v[24:27] offset:3072
    s_branch L_treedone
L_tree:
    v_lshrrev_b32 v18, 3, v8
    v_lshl_add_u32 v18, v18, 1, v20
    s_lshl_b32 s67, s36, 9
    s_add_u32 s67, s67, 1083392
    v_lshlrev_b32 v2, 7, v8
    v_mov_b32 v10, 0
    s_mov_b64 exec, 15
    buffer_atomic_swap v10, v2, s[48:51], s67 offen sc0
    s_mov_b64 exec, -1
    s_mul_i32 s43, s36, 384
    v_add_u32 v3, s43, v18
    v_add_u32 v7, s43, v20
    v_add_u32 v2, 0, v7
    global_load_dwordx4 v[56:59], v2, s[10:11] offset:0
    global_load_dwordx4 v[60:63], v2, s[10:11] offset:128
    global_load_dwordx4 v[64:67], v2, s[10:11] offset:256
    v_add_u32 v2, 0, v3
    global_load_ushort v68, v2, s[12:13] offset:0
    global_load_ushort v69, v2, s[12:13] offset:128
    global_load_ushort v70, v2, s[12:13] offset:256
    s_add_u32 s43, s36, 0
    s_lshr_b32 s43, s43, 5
    s_lshl_b32 s43, s43, 1
    v_mov_b32 v2, s43
    global_load_ushort v71, v2, s[14:15]
    v_add_u32 v2, 6144, v7
    global_load_dwordx4 v[72:75], v2, s[10:11] offset:0
    global_load_dwordx4 v[76:79], v2, s[10:11] offset:128
    global_load_dwordx4 v[80:83], v2, s[10:11] offset:256
    v_add_u32 v2, 6144, v3
    global_load_ushort v84, v2, s[12:13] offset:0
    global_load_ushort v85, v2, s[12:13] offset:128
    global_load_ushort v86, v2, s[12:13] offset:256
    s_add_u32 s43, s36, 16
    s_lshr_b32 s43, s43, 5
    s_lshl_b32 s43, s43, 1
    v_mov_b32 v2, s43
    global_load_ushort v87, v2, s[14:15]
    v_add_u32 v2, 12288, v7
    global_load_dwordx4 v[88:91], v2, s[10:11] offset:0
    global_load_dwordx4 v[92:95], v2, s[10:11] offset:128
    global_load_dwordx4 v[96:99], v2, s[10:11] offset:256
    v_add_u32 v2, 12288, v3
    global_load_ushort v100, v2, s[12:13] offset:0
    global_load_ushort v101, v2, s[12:13] offset:128
    global_load_ushort v102, v2, s[12:13] offset:256
    s_add_u32 s43, s36, 32
    s_lshr_b32 s43, s43, 5
    s_lshl_b32 s43, s43, 1
    v_mov_b32 v2, s43
    global_load_ushort v103, v2, s[14:15]
    v_add_u32 v2, 18432, v7
    global_load_dwordx4 v[104:107], v2, s[10:11] offset:0
    global_load_dwordx4 v[108:111], v2, s[10:11] offset:128
    global_load_dwordx4 v[112:115], v2, s[10:11] offset:256
    v_add_u32 v2, 18432, v3
    global_load_ushort v116, v2, s[12:13] offset:0
    global_load_ushort v117, v2, s[12:13] offset:128
    global_load_ushort v118, v2, s[12:13] offset:256
    s_add_u32 s43, s36, 48
    s_lshr_b32 s43, s43, 5
    s_lshl_b32 s43, s43, 1
    v_mov_b32 v2, s43
    global_load_ushort v119, v2, s[14:15]
    v_mov_b32 v15, 0xd04e79ff
    s_lshl_b32 s67, s36, 4
    v_mov_b32 v2, s67
    v_mov_b32 v11, 1
    s_waitcnt vmcnt(0)
    s_mov_b64 exec, 1
    global_atomic_add v2, v11, s[18:19]
    s_mov_b64 exec, -1
    ds_read_b128 v[120:123], v20 offset:512
    ds_read_b128 v[124:127], v20 offset:640
    ds_read_b128 v[128:131], v20 offset:768
    s_waitcnt lgkmcnt(0)
    v_dot2_f32_bf16 v12, v56, v120, 0
    v_dot2_f32_bf16 v13, v60, v124, 0
    v_dot2_f32_bf16 v14, v64, v128, 0
    v_dot2_f32_bf16 v12, v57, v121, v12
    v_dot2_f32_bf16 v13, v61, v125, v13
    v_dot2_f32_bf16 v14, v65, v129, v14
    v_dot2_f32_bf16 v12, v58, v122, v12
    v_dot2_f32_bf16 v13, v62, v126, v13
    v_dot2_f32_bf16 v14, v66, v130, v14
    v_dot2_f32_bf16 v12, v59, v123, v12
    v_dot2_f32_bf16 v13, v63, v127, v13
    v_dot2_f32_bf16 v14, v67, v131, v14
    v_lshlrev_b32 v68, 16, v68
    v_lshlrev_b32 v69, 16, v69
    v_lshlrev_b32 v70, 16, v70
    v_lshlrev_b32 v71, 16, v71
    v_add_f32 v12, v12, v13
    v_add_f32 v12, v12, v14
    s_nop 1
    v_add_f32_dpp v12, v12, v12 quad_perm:[1,0,3,2] row_mask:0xf bank_mask:0xf
    s_nop 1
    v_add_f32_dpp v12, v12, v12 quad_perm:[2,3,0,1] row_mask:0xf bank_mask:0xf
    s_nop 1
    v_add_f32_dpp v12, v12, v12 row_half_mirror row_mask:0xf bank_mask:0xf
    v_sub_f32 v71, 1.0, v71
    v_fma_f32 v12, v71, v15, v12
    v_cndmask_b32 v71, 1.0, v12, s[44:45]
    ds_write_b128 v19, v[68:71] offset:0
    ds_read_b128 v[120:123], v20 offset:896
    ds_read_b128 v[124:127], v20 offset:1024
    ds_read_b128 v[128:131], v20 offset:1152
    s_waitcnt lgkmcnt(0)
    v_dot2_f32_bf16 v12, v72, v120, 0
    v_dot2_f32_bf16 v13, v76, v124, 0
    v_dot2_f32_bf16 v14, v80, v128, 0
    v_dot2_f32_bf16 v12, v73, v121, v12
    v_dot2_f32_bf16 v13, v77, v125, v13
    v_dot2_f32_bf16 v14, v81, v129, v14
    v_dot2_f32_bf16 v12, v74, v122, v12
    v_dot2_f32_bf16 v13, v78, v126, v13
    v_dot2_f32_bf16 v14, v82, v130, v14
    v_dot2_f32_bf16 v12, v75, v123, v12
    v_dot2_f32_bf16 v13, v79, v127, v13
    v_dot2_f32_bf16 v14, v83, v131, v14
    v_lshlrev_b32 v84, 16, v84
    v_lshlrev_b32 v85, 16, v85
    v_lshlrev_b32 v86, 16, v86
    v_lshlrev_b32 v87, 16, v87
    v_add_f32 v12, v12, v13
    v_add_f32 v12, v12, v14
    s_nop 1
    v_add_f32_dpp v12, v12, v12 quad_perm:[1,0,3,2] row_mask:0xf bank_mask:0xf
    s_nop 1
    v_add_f32_dpp v12, v12, v12 quad_perm:[2,3,0,1] row_mask:0xf bank_mask:0xf
    s_nop 1
    v_add_f32_dpp v12, v12, v12 row_half_mirror row_mask:0xf bank_mask:0xf
    v_sub_f32 v87, 1.0, v87
    v_fma_f32 v12, v87, v15, v12
    v_cndmask_b32 v87, 1.0, v12, s[44:45]
    ds_write_b128 v19, v[84:87] offset:1024
    ds_read_b128 v[120:123], v20 offset:1280
    ds_read_b128 v[124:127], v20 offset:1408
    ds_read_b128 v[128:131], v20 offset:1536
    s_waitcnt lgkmcnt(0)
    v_dot2_f32_bf16 v12, v88, v120, 0
    v_dot2_f32_bf16 v13, v92, v124, 0
    v_dot2_f32_bf16 v14, v96, v128, 0
    v_dot2_f32_bf16 v12, v89, v121, v12
    v_dot2_f32_bf16 v13, v93, v125, v13
    v_dot2_f32_bf16 v14, v97, v129, v14
    v_dot2_f32_bf16 v12, v90, v122, v12
    v_dot2_f32_bf16 v13, v94, v126, v13
    v_dot2_f32_bf16 v14, v98, v130, v14
    v_dot2_f32_bf16 v12, v91, v123, v12
    v_dot2_f32_bf16 v13, v95, v127, v13
    v_dot2_f32_bf16 v14, v99, v131, v14
    v_lshlrev_b32 v100, 16, v100
    v_lshlrev_b32 v101, 16, v101
    v_lshlrev_b32 v102, 16, v102
    v_lshlrev_b32 v103, 16, v103
    v_add_f32 v12, v12, v13
    v_add_f32 v12, v12, v14
    s_nop 1
    v_add_f32_dpp v12, v12, v12 quad_perm:[1,0,3,2] row_mask:0xf bank_mask:0xf
    s_nop 1
    v_add_f32_dpp v12, v12, v12 quad_perm:[2,3,0,1] row_mask:0xf bank_mask:0xf
    s_nop 1
    v_add_f32_dpp v12, v12, v12 row_half_mirror row_mask:0xf bank_mask:0xf
    v_sub_f32 v103, 1.0, v103
    v_fma_f32 v12, v103, v15, v12
    v_cndmask_b32 v103, 1.0, v12, s[44:45]
    ds_write_b128 v19, v[100:103] offset:2048
    ds_read_b128 v[120:123], v20 offset:1664
    ds_read_b128 v[124:127], v20 offset:1792
    ds_read_b128 v[128:131], v20 offset:1920
    s_waitcnt lgkmcnt(0)
    v_dot2_f32_bf16 v12, v104, v120, 0
    v_dot2_f32_bf16 v13, v108, v124, 0
    v_dot2_f32_bf16 v14, v112, v128, 0
    v_dot2_f32_bf16 v12, v105, v121, v12
    v_dot2_f32_bf16 v13, v109, v125, v13
    v_dot2_f32_bf16 v14, v113, v129, v14
    v_dot2_f32_bf16 v12, v106, v122, v12
    v_dot2_f32_bf16 v13, v110, v126, v13
    v_dot2_f32_bf16 v14, v114, v130, v14
    v_dot2_f32_bf16 v12, v107, v123, v12
    v_dot2_f32_bf16 v13, v111, v127, v13
    v_dot2_f32_bf16 v14, v115, v131, v14
    v_lshlrev_b32 v116, 16, v116
    v_lshlrev_b32 v117, 16, v117
    v_lshlrev_b32 v118, 16, v118
    v_lshlrev_b32 v119, 16, v119
    v_add_f32 v12, v12, v13
    v_add_f32 v12, v12, v14
    s_nop 1
    v_add_f32_dpp v12, v12, v12 quad_perm:[1,0,3,2] row_mask:0xf bank_mask:0xf
    s_nop 1
    v_add_f32_dpp v12, v12, v12 quad_perm:[2,3,0,1] row_mask:0xf bank_mask:0xf
    s_nop 1
    v_add_f32_dpp v12, v12, v12 row_half_mirror row_mask:0xf bank_mask:0xf
    v_sub_f32 v119, 1.0, v119
    v_fma_f32 v12, v119, v15, v12
    v_cndmask_b32 v119, 1.0, v12, s[44:45]
    ds_write_b128 v19, v[116:119] offset:3072
L_treedone:
    s_mov_b32 s30, 0
    s_getreg_b32 s68, hwreg(HW_REG_XCC_ID)
    s_and_b32 s68, s68, 15
    s_lshl_b32 s68, s68, 7
    s_add_u32 s68, s68, 1081344
    v_lshlrev_b32 v21, 7, v8
    s_lshr_b32 s29, s2, 4
    s_and_b32 s43, s2, 15
    s_cmp_eq_u32 s29, s43
    s_cselect_b32 s41, 1, 0
    s_cmp_lt_u32 s29, 16
    s_cselect_b32 s40, s41, 0
    s_lshl_b32 s43, s29, 7
    v_mov_b32 v23, s43
    s_mov_b32 s39, 1048576
    s_movk_i32 s65, 16384
    s_mov_b64 exec, 1
    s_waitcnt lgkmcnt(0)
L_hp:
    s_lshl_b32 s43, s30, 2
    v_mov_b32 v3, s43
L_hwait:
    s_sleep 6
    s_cmp_lg_u32 s40, 0
    s_cbranch_scc1 L_hnoref
    s_cmp_lt_u32 s30, 2
    s_cbranch_scc1 L_hnoref
    buffer_load_dwordx3 v[52:54], v55, s[48:51], s68 offen sc1
    s_waitcnt vmcnt(0)
    v_readfirstlane_b32 s43, v53
    v_readfirstlane_b32 s29, v52
    s_nop 0
    s_sub_u32 s43, s43, s34
    s_cmp_lt_u32 s43, s65
    s_cbranch_scc0 L_hnoref
    s_cmp_le_u32 s29, 128
    s_cbranch_scc0 L_hnoref
    ds_write_b96 v55, v[52:54] offset:16
L_hnoref:
    ds_read_b32 v15, v3 offset:64
    s_waitcnt lgkmcnt(0)
    v_readfirstlane_b32 s31, v15
    s_nop 1
    s_cmp_eq_u32 s31, 0
    s_cbranch_scc1 L_hwait
    s_cmp_eq_u32 s41, 0
    s_cbranch_scc1 L_hnext
    buffer_store_dword v15, v23, s[48:51], s39 offen sc1
    s_cmp_eq_u32 s40, 0
    s_cbranch_scc1 L_hnext
    s_mov_b64 exec, 0xffff
    s_mov_b32 s69, 3
L_hgather:
    s_sleep 20
    buffer_load_dword v22, v21, s[48:51], s39 offen sc1
    s_sub_u32 s69, s69, 1
    s_waitcnt vmcnt(0)
    v_subrev_u32 v22, s34, v22
    v_cmp_le_u32 vcc, s65, v22
    s_nop 4
    s_cbranch_vccz L_hall
    s_cmp_lg_u32 s69, 0
    s_cbranch_scc1 L_hgather
    s_sub_u32 s29, s31, s34
    s_add_u32 s29, s29, 250
    v_mov_b32 v2, s29
    v_cndmask_b32 v22, v22, v2, vcc
L_hall:
    s_nop 1
    v_add_u32_dpp v22, v22, v22 quad_perm:[1,0,3,2] row_mask:0xf bank_mask:0xf
    s_nop 1
    v_add_u32_dpp v22, v22, v22 quad_perm:[2,3,0,1] row_mask:0xf bank_mask:0xf
    s_nop 1
    v_add_u32_dpp v22, v22, v22 row_half_mirror row_mask:0xf bank_mask:0xf
    s_nop 1
    v_add_u32_dpp v22, v22, v22 row_mirror row_mask:0xf bank_mask:0xf
    v_lshrrev_b32 v22, 4, v22
    v_add_u32 v53, s34, v22
    s_mov_b64 exec, 1
    v_readfirstlane_b32 s31, v53
    s_add_u32 s43, s30, 1
    s_mul_i32 s43, s43, 8
    v_mov_b32 v52, s43
    s_sub_u32 s29, s31, s47
    s_lshl_b32 s29, s29, 1
    s_sub_u32 s43, s31, s46
    s_cmp_eq_u32 s30, 1
    s_cselect_b32 s43, s29, s43
    v_mov_b32 v54, s43
    s_mov_b32 s46, s47
    s_mov_b32 s47, s31
    s_cmp_eq_u32 s30, 0
    s_cbranch_scc1 L_hnext
    buffer_store_dwordx3 v[52:54], v55, s[48:51], s68 offen
    ds_write_b96 v55, v[52:54] offset:16
L_hnext:
    s_add_u32 s39, s39, 2048
    s_add_u32 s30, s30, 1
    s_add_u32 s43, s30, s41
    s_cmp_lt_u32 s43, 15
    s_cbranch_scc1 L_hp
    s_lshl_b32 s67, s36, 4
    s_load_dword s66, s[18:19], s67
L_rdy:
    s_waitcnt lgkmcnt(0)
    s_cmp_lg_u32 s66, 0
    s_cbranch_scc1 L_rdyok
    s_sleep 16
    s_atomic_add s66, s[18:19], s67 glc
    s_branch L_rdy
L_rdyok:
    s_barrier
L_end:
    s_endpgm
.section .rodata,"a"
.p2align 6
.amdhsa_kernel standalone__tree_speculative_verify_tree_attention_over_candidate_token_tree__decode_kernel
  .amdhsa_next_free_vgpr 140
  .amdhsa_next_free_sgpr 96
  .amdhsa_accum_offset 140
  .amdhsa_group_segment_fixed_size 0
  .amdhsa_kernarg_size 72
  .amdhsa_user_sgpr_count 2
  .amdhsa_user_sgpr_kernarg_segment_ptr 1
  .amdhsa_system_sgpr_workgroup_id_x 1
.end_amdhsa_kernel
```
